```python
import torch

def _softmax(x, axis=-1):
    return torch.softmax(x, dim=axis)
def _gelu(x):
    return torch.nn.functional.gelu(x, approximate="tanh")
def _silu(x):
    return torch.nn.functional.silu(x)
def _sigmoid(x):
    return torch.sigmoid(x)
def _layernorm(x, axis=-1, eps=1e-5):
    m = x.mean(dim=axis, keepdim=True)
    v = x.var(dim=axis, keepdim=True, unbiased=False)
    return (x - m) / torch.sqrt(v + eps)
def _scatter_add(tgt, idx, src, axis=0):
    return tgt.clone().index_add_(axis, idx, src)
def _segment_sum(src, seg, n):
    out = torch.zeros((n,) + src.shape[1:], dtype=src.dtype)
    return out.index_add_(0, seg, src)
def _pad(x, pw):
    flat = tuple(v for pair in reversed(pw) for v in pair)
    return torch.nn.functional.pad(x, flat)

kernel_name = 'standalone__mpnn_edge_mlp__graph'

def setup_inputs():

    _w = (lambda a: (lambda t: t.to(torch.bfloat16) if t.is_floating_point() else t)(torch.as_tensor(a)))
    N, deg, D, De = 10000, 32, 128, max(4, 1)
    E = N * deg
    return {
        "x": _w((lambda *s: torch.randn(*s, dtype=torch.bfloat16) * 0.05)(N, D)),
        "e_attr": _w((lambda *s: torch.randn(*s, dtype=torch.bfloat16) * 0.4)(E, De)),
        "src": _w((lambda lo, hi, *s: torch.randint(lo, hi, s))(0, N, E).to(torch.int64)),
        "dst": _w((lambda lo, hi, *s: torch.randint(lo, hi, s))(0, N, E).to(torch.int64)),
        "w_msg": _w((lambda *s: torch.randn(*s, dtype=torch.bfloat16) * 0.4)(2 * D + De, D)),
        "w_upd": _w((lambda *s: torch.randn(*s, dtype=torch.bfloat16) * 0.05)(2 * D, D)),
    }

def reference(x, e_attr, src, dst, w_msg, w_upd):
    N, D = x.shape
    m_in = torch.concatenate([x[src], x[dst], e_attr], axis=-1)
    msg = _silu(m_in @ w_msg)
    agg = _segment_sum(msg, dst, N)
    return _silu(torch.concatenate([x, agg], axis=-1) @ w_upd)
```

```asm
; @launch grid=(256,1,1) block=(1024,1,1) lds=163328
.amdgcn_target "amdgcn-amd-amdhsa--gfx950"
.text
.globl standalone__mpnn_edge_mlp__graph_kernel
.p2align 8
.type standalone__mpnn_edge_mlp__graph_kernel,@function
standalone__mpnn_edge_mlp__graph_kernel:
    s_cmp_gt_u32 s2, 255
    s_cbranch_scc1 K_END
    s_load_dwordx2 s[68:69], s[0:1], 24
    s_load_dwordx2 s[72:73], s[0:1], 16
    s_load_dwordx2 s[76:77], s[0:1], 8
    s_load_dwordx2 s[24:25], s[0:1], 0
    s_load_dwordx2 s[4:5], s[0:1], 32
    s_load_dwordx2 s[64:65], s[0:1], 56
    s_load_dwordx2 s[28:29], s[0:1], 64
    s_load_dwordx2 s[36:37], s[0:1], 48
    v_lshrrev_b32 v2, 6, v0
    v_and_b32 v127, 63, v0
    v_mov_b32 v8, 0
    v_mov_b32 v10, 0
    v_lshlrev_b32 v108, 7, v0
    s_getpc_b64 s[12:13]
KP_PC:
    v_readfirstlane_b32 s3, v2
    v_cmpx_gt_u32 vcc, K_LAST-KP_PC, v108
    s_and_b32 s56, s2, 7
    s_lshl_b32 s56, s56, 5
    s_lshr_b32 s59, s2, 3
    s_add_u32 s62, s56, s59
    s_mov_b32 s66, 0x100
    s_mov_b32 s67, 0x20000
    s_cbranch_execz KP_PC2
    global_load_dword v107, v108, s[12:13]
KP_PC2:
    s_mov_b64 exec, -1
    s_cmp_ge_u32 s62, 250
    s_cbranch_scc1 K_OTHER
    s_cmp_lt_u32 s3, 5
    s_cselect_b32 s41, 1, 0
    s_cbranch_scc0 KP_HZ
    s_lshl_b32 s11, s3, 10
    v_lshl_add_u32 v10, v127, 4, s11
    s_mul_i32 s12, s62, 5120
    v_lshlrev_b32 v11, 1, v10
    s_mul_i32 s13, s62, 10240
    s_mov_b32 s70, 0x138800
    s_mov_b32 s71, 0x20000
    s_mov_b32 s74, 0x138800
    s_mov_b32 s75, 0x20000
    s_mov_b32 s78, 0x271000
    s_mov_b32 s79, 0x20000
    s_waitcnt lgkmcnt(0)
    buffer_load_dwordx4 v[12:15], v10, s[68:71], s12 offen nt
    s_barrier
    buffer_load_dwordx4 v[16:19], v10, s[72:75], s12 offen nt
    buffer_load_dwordx4 v[20:23], v11, s[76:79], s13 offen nt
    buffer_load_dwordx4 v[24:27], v11, s[76:79], s13 offen offset:16 nt
    v_and_b32 v127, 63, v0
    v_lshrrev_b32 v122, 4, v127
    v_and_b32 v123, 15, v127
    v_xor_b32 v3, v123, v122
    v_lshlrev_b32 v3, 4, v3
    v_lshl_add_u32 v5, v122, 8, v3
    s_lshl_b32 s56, s3, 6
    v_lshrrev_b32 v6, 1, v123
    v_xor_b32 v6, v6, v122
    v_lshlrev_b32 v6, 5, v6
    v_lshl_add_u32 v6, v122, 8, v6
    v_and_b32 v7, 1, v127
    v_lshl_add_u32 v6, v7, 4, v6
    s_and_b32 s56, s56, 128
    v_xor_b32 v6, s56, v6
    s_lshl_b32 s57, s3, 10
    s_add_u32 s58, s57, 16384
    s_branch KP_E
KP_HZ:
    s_cmp_lt_u32 s3, 12
    s_cbranch_scc1 KP_HZ0
    s_mul_i32 s10, s3, 10240
    s_sub_u32 s10, s10, 67072
    v_mov_b32 v12, 0
    v_mov_b32 v13, 0
    v_mov_b32 v14, -1
    v_lshl_add_u32 v15, v127, 4, s10
    ds_write_b128 v15, v[12:15] offset:0
    ds_write_b128 v15, v[12:15] offset:1024
    ds_write_b128 v15, v[12:15] offset:2048
    ds_write_b128 v15, v[12:15] offset:3072
    ds_write_b128 v15, v[12:15] offset:4096
    ds_write_b128 v15, v[12:15] offset:5120
    ds_write_b128 v15, v[12:15] offset:6144
    ds_write_b128 v15, v[12:15] offset:7168
    ds_write_b128 v15, v[12:15] offset:8192
    ds_write_b128 v15, v[12:15] offset:9216
    s_waitcnt lgkmcnt(0)
    s_barrier
KP_HZ0:
    v_and_b32 v127, 63, v0
    v_lshrrev_b32 v122, 4, v127
    v_and_b32 v123, 15, v127
    v_xor_b32 v3, v123, v122
    v_lshlrev_b32 v3, 4, v3
    v_lshl_add_u32 v5, v122, 8, v3
    s_lshl_b32 s56, s3, 6
    v_lshrrev_b32 v6, 1, v123
    v_xor_b32 v6, v6, v122
    v_lshlrev_b32 v6, 5, v6
    v_lshl_add_u32 v6, v122, 8, v6
    v_and_b32 v7, 1, v127
    v_lshl_add_u32 v6, v7, 4, v6
    s_and_b32 s56, s56, 128
    v_xor_b32 v6, s56, v6
    s_lshl_b32 s57, s3, 10
    s_add_u32 s58, s57, 16384
    s_mov_b32 s26, 0x271000
    s_mov_b32 s27, 0x20000
    s_mov_b32 s6, 0x10400
    s_mov_b32 s7, 0x20000
    s_cmp_lt_u32 s3, 12
    s_cbranch_scc0 KP_HZ1
    s_mov_b32 s41, 2
    s_cmp_ge_u32 s3, 8
    s_cbranch_scc1 KP_DW
    s_memrealtime s[60:61]
    s_sub_u32 s10, s3, 5
    v_mov_b32 v9, 0
    v_mov_b32 v10, 0
    v_mov_b32 v11, 0
    s_mul_i32 s59, s10, 2048
    v_lshl_add_u32 v15, v127, 4, s59
    s_lshl_b32 s11, s10, 12
    s_mul_i32 s56, s62, 10240
    s_add_u32 s56, s56, s11
    v_xor_b32 v12, 64, v5
    v_xor_b32 v13, 128, v5
    v_xor_b32 v14, 192, v5
    s_add_u32 m0, s11, 22528
    s_cmp_eq_u32 s3, 7
    s_cselect_b32 s59, 0x40000000, s56
    s_cbranch_scc1 KP_HZ2
    ds_write_b128 v15, v[8:11]
    s_branch KP_DX
KP_HZ2:
    s_cmp_lg_u32 s2, 0
    s_cbranch_scc1 KP_DX
    s_waitcnt lgkmcnt(0)
    s_or_b32 s60, s60, 0x80000000
    v_mov_b32 v2, s60
    v_lshlrev_b32 v4, 6, v127
    buffer_store_dword v2, v4, s[64:67], 0 offen sc1
KP_DX:
    s_waitcnt lgkmcnt(0)
    buffer_load_dwordx4 v5, s[24:27], s56 offen offset:0 nt lds
    buffer_load_dwordx4 v12, s[24:27], s56 offen offset:1024 nt lds
    buffer_load_dwordx4 v13, s[24:27], s59 offen offset:2048 nt lds
    buffer_load_dwordx4 v14, s[24:27], s59 offen offset:3072 nt lds
    s_barrier
    s_branch KP_E
KP_DW:
    s_and_b32 s57, s57, 3072
    s_lshl_b32 s11, s2, 9
    s_waitcnt lgkmcnt(0)
    s_and_b32 s11, s11, 0x7000
    s_add_u32 s56, s57, s11
    s_add_u32 m0, s56, 96768
    s_add_u32 s11, s11, 4096
    buffer_load_dwordx4 v6, s[4:7], s56 offen lds
    s_and_b32 s11, s11, 0x7000
    s_add_u32 s56, s57, s11
    s_add_u32 m0, s56, 96768
    s_add_u32 s11, s11, 4096
    buffer_load_dwordx4 v6, s[4:7], s56 offen lds
    s_and_b32 s11, s11, 0x7000
    s_add_u32 s56, s57, s11
    s_add_u32 m0, s56, 96768
    s_add_u32 s11, s11, 4096
    buffer_load_dwordx4 v6, s[4:7], s56 offen lds
    s_and_b32 s11, s11, 0x7000
    s_add_u32 s56, s57, s11
    s_add_u32 m0, s56, 96768
    s_add_u32 s11, s11, 4096
    buffer_load_dwordx4 v6, s[4:7], s56 offen lds
    s_and_b32 s11, s11, 0x7000
    s_add_u32 s56, s57, s11
    s_add_u32 m0, s56, 96768
    s_add_u32 s11, s11, 4096
    buffer_load_dwordx4 v6, s[4:7], s56 offen lds
    s_and_b32 s11, s11, 0x7000
    s_add_u32 s56, s57, s11
    s_add_u32 m0, s56, 96768
    s_add_u32 s11, s11, 4096
    buffer_load_dwordx4 v6, s[4:7], s56 offen lds
    s_and_b32 s11, s11, 0x7000
    s_add_u32 s56, s57, s11
    s_add_u32 m0, s56, 96768
    s_add_u32 s11, s11, 4096
    buffer_load_dwordx4 v6, s[4:7], s56 offen lds
    s_and_b32 s11, s11, 0x7000
    s_add_u32 s56, s57, s11
    s_add_u32 m0, s56, 96768
    s_add_u32 s11, s11, 4096
    buffer_load_dwordx4 v6, s[4:7], s56 offen lds
    s_barrier
    s_branch KP_E
KP_HZ1:
    s_waitcnt lgkmcnt(0)
KP_E:
    v_lshlrev_b32 v29, 4, v127
    s_mov_b32 s30, 0x10000000
    s_mov_b32 s31, 0x20000
    s_add_u32 s32, s28, 256
    s_addc_u32 s33, s29, 0x1000000
    s_mov_b32 s34, 0x2710
    s_mov_b32 s35, 0x20000
    s_mov_b32 s38, 0x271000
    s_mov_b32 s39, 0x20000
    v_lshrrev_b32 v44, 2, v0
    v_and_b32 v121, 3, v0
    v_mul_u32_u24 v120, 20736, v44
    v_min_u32 v126, 249, v44
    v_mul_u32_u24 v126, 2304, v126
    v_lshlrev_b32 v119, 2, v44
    v_cmp_lt_u32 vcc, 249, v44
    v_lshl_add_u32 v120, v121, 4, v120
    v_mov_b32 v44, 0x10000
    v_add_u32 v119, 162304, v119
    v_cndmask_b32 v121, v121, v44, vcc
    s_lshr_b32 s61, s62, 2
    s_lshl_b32 s61, s61, 4
    s_bfe_u32 s56, s62, 0x10001
    s_lshl_b32 s56, s56, 10
    s_add_u32 s61, s61, s56
    s_and_b32 s56, s62, 1
    s_lshl_b32 s56, s56, 3
    s_add_u32 s61, s61, s56
    s_add_u32 s61, s61, 0x780000
    s_bitcmp0_b32 s41, 0
    s_cbranch_scc1 KP_NS
    s_setprio 2
    v_mov_b32 v28, 4
    s_mov_b32 s60, -40
    v_lshrrev_b32 v30, 1, v10
    v_lshrrev_b32 v31, 2, v10
    s_waitcnt vmcnt(3)
    v_mul_u32_u24 v32, 0xcccd, v12
    v_mul_u32_u24 v33, 0xcccd, v13
    v_mul_u32_u24 v34, 0xcccd, v14
    v_mul_u32_u24 v35, 0xcccd, v15
    v_lshrrev_b32 v32, 21, v32
    v_lshrrev_b32 v33, 21, v33
    v_lshrrev_b32 v34, 21, v34
    v_lshrrev_b32 v35, 21, v35
    v_mad_i32_i24 v40, v32, s60, v12
    v_lshlrev_b32 v32, 2, v32
    ds_add_rtn_u32 v36, v32, v28 offset:2048
    v_mad_i32_i24 v41, v33, s60, v13
    v_lshlrev_b32 v33, 2, v33
    ds_add_rtn_u32 v37, v33, v28 offset:2048
    v_mad_i32_i24 v42, v34, s60, v14
    v_lshlrev_b32 v34, 2, v34
    ds_add_rtn_u32 v38, v34, v28 offset:2048
    v_mad_i32_i24 v43, v35, s60, v15
    v_lshlrev_b32 v35, 2, v35
    ds_add_rtn_u32 v39, v35, v28 offset:2048
    s_mov_b64 exec, 1
    v_mov_b32 v28, 1
    ds_add_u32 v8, v28 offset:204
    s_mov_b64 exec, -1
KP_S1:
    s_mov_b32 s59, 65536
    s_branch KP_S1M
KP_S1L:
    s_sleep 1
KP_S1M:
    ds_read_b32 v48, v8 offset:204
    ds_read_b128 v[44:47], v29 offset:2048
    s_sub_u32 s59, s59, 1
    s_cbranch_scc1 K_END
    s_waitcnt lgkmcnt(1)
    v_readfirstlane_b32 s56, v48
    s_cmp_lt_u32 s56, 5
    s_waitcnt lgkmcnt(0)
    s_cbranch_scc1 KP_S1L
    v_add_u32 v49, v44, v45
    v_add_u32 v50, v49, v46
    v_add_u32 v51, v50, v47
    s_nop 1
    v_add_u32_dpp v52, v51, v51 row_shr:1 row_mask:0xf bank_mask:0xf bound_ctrl:0
    s_nop 1
    v_add_u32_dpp v52, v52, v52 row_shr:2 row_mask:0xf bank_mask:0xf
    s_nop 1
    v_add_u32_dpp v52, v52, v52 row_shr:4 row_mask:0xf bank_mask:0xf
    s_nop 1
    v_add_u32_dpp v52, v52, v52 row_shr:8 row_mask:0xf bank_mask:0xf
    s_nop 1
    v_add_u32_dpp v52, v52, v52 row_bcast:15 row_mask:0xa bank_mask:0xf
    s_nop 1
    v_add_u32_dpp v52, v52, v52 row_bcast:31 row_mask:0xc bank_mask:0xf
    v_sub_u32 v52, v52, v51
    v_add_u32 v53, v52, v44
    v_add_u32 v54, v52, v49
    v_add_u32 v55, v52, v50
    s_cmp_lg_u32 s3, 14
    s_cbranch_scc1 KP_W2
    v_lshl_or_b32 v60, v44, 12, v52
    v_lshlrev_b32 v60, 2, v60
    v_lshl_or_b32 v62, v45, 12, v53
    v_lshlrev_b32 v62, 2, v62
    v_lshl_or_b32 v64, v46, 12, v54
    v_lshlrev_b32 v64, 2, v64
    v_lshl_or_b32 v66, v47, 12, v55
    v_lshlrev_b32 v66, 2, v66
    s_mul_i32 s56, s62, 2304
    s_add_u32 s56, s56, 0x780000
    s_mov_b32 s59, 65536
    s_branch K_SPM2
K_SP1:
    s_sleep 1
K_SPM2:
    ds_read_b32 v61, v8 offset:192
    s_sub_u32 s59, s59, 1
    s_cbranch_scc1 K_END
    s_waitcnt lgkmcnt(0)
    v_readfirstlane_b32 s10, v61
    s_cmp_lt_u32 s10, 1
    s_cbranch_scc1 K_SP1
    s_lshl_b32 s19, s10, 28
    s_lshr_b32 s19, s19, 4
    s_add_u32 s56, s56, s19
    v_mov_b32 v63, v61
    v_mov_b32 v65, v61
    v_mov_b32 v67, v61
    buffer_store_dwordx4 v[60:63], v29, s[28:31], s56 offen sc1
    buffer_store_dwordx4 v[64:67], v29, s[28:31], s56 offen offset:1024 sc1
    s_setprio 0
    s_branch KP_C
KP_NS:
    s_bitcmp1_b32 s41, 1
    s_cbranch_scc1 K_PST
    s_cmp_eq_u32 s3, 12
    s_cbranch_scc1 KP_TP
    s_setprio 3
    s_cmp_eq_u32 s3, 14
    s_cbranch_scc1 KP_S1
    s_cmp_eq_u32 s3, 15
    s_cbranch_scc1 KP_W3
    s_memrealtime s[10:11]
    s_sleep 6
    s_load_dword s47, s[64:65], 0
    s_waitcnt lgkmcnt(0)
    s_sub_u32 s56, s10, s47
    s_add_u32 s56, s56, 0x100000
    s_and_b32 s56, s56, 0x7fe00000
    s_lshr_b32 s57, s47, 31
    s_cmp_lt_u32 s56, s57
    s_cbranch_scc1 KP_TAGK
    s_load_dword s47, s[64:65], 64
    s_waitcnt lgkmcnt(0)
    s_sub_u32 s56, s10, s47
    s_add_u32 s56, s56, 0x100000
    s_and_b32 s56, s56, 0x7fe00000
    s_lshr_b32 s57, s47, 31
    s_cmp_lt_u32 s56, s57
    s_cbranch_scc1 KP_TAGK
    s_load_dword s47, s[64:65], 128
    s_waitcnt lgkmcnt(0)
    s_sub_u32 s56, s10, s47
    s_add_u32 s56, s56, 0x100000
    s_and_b32 s56, s56, 0x7fe00000
    s_lshr_b32 s57, s47, 31
    s_cmp_lt_u32 s56, s57
    s_cbranch_scc1 KP_TAGK
    s_load_dword s47, s[64:65], 192
    s_waitcnt lgkmcnt(0)
    s_sub_u32 s56, s10, s47
    s_add_u32 s56, s56, 0x100000
    s_and_b32 s56, s56, 0x7fe00000
    s_lshr_b32 s57, s47, 31
    s_cmp_lt_u32 s56, s57
    s_cbranch_scc1 KP_TAGK
    s_mov_b32 s59, 65536
K_TAGL3:
    buffer_load_dword v2, v8, s[64:67], 0 offen sc1
    s_sub_u32 s59, s59, 1
    s_cbranch_scc1 K_END
    s_waitcnt vmcnt(0)
    v_readfirstlane_b32 s47, v2
    s_sub_u32 s56, s10, s47
    s_add_u32 s56, s56, 0x100000
    s_and_b32 s56, s56, 0x7fe00000
    s_lshr_b32 s57, s47, 31
    s_cmp_lt_u32 s56, s57
    s_cbranch_scc0 K_TAGL3
KP_TAGK:
    v_mov_b32 v9, s47
    ds_write_b32 v8, v9 offset:192
    v_mov_b32 v58, 16
    v_lshlrev_b32 v69, 2, v127
    v_and_b32 v104, 7, v127
    v_subrev_u32 v82, 640, v0
    v_cmp_eq_u32 vcc, 0, v104
    v_lshrrev_b32 v82, 3, v82
    v_lshlrev_b32 v81, 9, v82
    v_lshlrev_b32 v80, 6, v104
    v_or_b32 v83, 0x40000, v81
    v_lshl_add_u32 v80, v82, 10, v80
    v_lshlrev_b32 v82, 2, v82
    v_add_u32 v80, 56192, v80
    v_cndmask_b32 v81, v81, v83, vcc
    v_lshlrev_b32 v83, 3, v104
    v_and_b32 v73, 3, v127
    v_cmp_eq_u32 vcc, v73, v122
    v_lshlrev_b32 v70, 3, v122
    v_lshlrev_b32 v71, 1, v127
    v_mov_b32 v73, 0x40000
    v_and_b32 v71, 24, v71
    v_cndmask_b32 v73, v73, 0, vcc
    v_mov_b32 v106, 0
    v_bfe_u32 v55, v127, 2, 2
    v_cmp_eq_u32 vcc, v55, v122
    v_and_b32 v55, 1, v127
    v_lshlrev_b32 v55, 4, v55
    v_mov_b32 v56, 0x3f80
    v_lshlrev_b32 v55, v55, v56
    v_cndmask_b32 v55, 0, v55, vcc
    v_and_b32 v56, 2, v127
    v_cmp_eq_u32 vcc, 0, v56
    v_lshrrev_b32 v53, 3, v127
    s_lshl_b32 s10, s3, 11
    v_lshl_add_u32 v53, v53, 9, s10
    v_lshlrev_b32 v52, 6, v104
    v_lshl_add_u32 v52, v53, 1, v52
    s_lshl_b32 s10, s3, 8
    v_lshl_add_u32 v54, v127, 3, s10
    v_add_u32 v52, 55808, v52
    s_cmp_lt_u32 s3, 10
    s_cselect_b32 exec_lo, -1, 0
    s_mov_b32 exec_hi, 0
    ds_write_b64 v54, v[52:53] offset:4608
    s_mov_b64 exec, -1
    s_sub_u32 s10, s3, 10
    s_lshr_b32 s11, s10, 1
    s_and_b32 s10, s10, 1
    s_lshl_b32 s11, s11, 2
    s_lshr_b32 s11, 0x402, s11
    s_and_b32 s11, s11, 15
    s_add_u32 s10, s10, s11
    s_lshl_b32 s10, s10, 11
    s_add_u32 s10, s10, 117248
    v_lshl_add_u32 v125, v122, 9, s10
    s_mov_b32 s79, 0x40000
    v_cndmask_b32 v32, 0, v55, vcc
    v_cndmask_b32 v33, v55, 0, vcc
    v_mov_b32 v36, v32
    v_mov_b32 v37, v33
    v_mov_b32 v40, v32
    v_mov_b32 v41, v33
    v_mov_b32 v44, v32
    v_mov_b32 v45, v33
    v_mov_b32 v48, v32
    v_mov_b32 v49, v33
    v_lshlrev_b32 v111, 4, v123
    v_lshlrev_b32 v113, 4, v123
    v_lshlrev_b32 v115, 4, v123
    v_lshlrev_b32 v117, 4, v123
    v_lshlrev_b32 v6, 4, v127
    s_mov_b32 s44, 1.0
    s_mov_b32 s45, 1.0
    s_mov_b32 s46, 0x5f800000
    s_mov_b32 s56, 0xbfb8aa3b
    s_mov_b32 s57, 0xbfb8aa3b
    s_mov_b32 s60, 0x3ffff
    s_mov_b32 s63, 0x280000
    s_mov_b32 s40, 0
    s_sleep 50
    ds_write_b32 v8, v9 offset:212
    s_setprio 0
    s_branch KP_G
KP_W3:
    s_setprio 0
    s_bfe_u32 s11, s2, 0x30003
    s_mul_i32 s11, s11, 4224
    s_add_u32 s11, s11, 32768
    v_lshlrev_b32 v108, 7, v127
    s_mov_b32 exec_hi, 1
    buffer_load_dword v107, v108, s[4:7], s11 offen
    s_mov_b32 exec_hi, -1
    v_lshrrev_b32 v12, 3, v123
    v_lshlrev_b32 v12, 7, v12
    v_lshl_add_u32 v12, v122, 5, v12
    v_and_b32 v13, 7, v123
    v_lshl_add_u32 v12, v13, 2, v12
    s_mov_b32 s56, 65536
    buffer_load_dword v70, v12, s[4:7], s56 offen offset:0
    buffer_load_dword v71, v12, s[4:7], s56 offen offset:256
    buffer_load_dword v72, v12, s[4:7], s56 offen offset:512
    buffer_load_dword v73, v12, s[4:7], s56 offen offset:768
    v_xor_b32 v5, 128, v6
    s_lshl_b32 s11, s2, 9
    s_mov_b32 s13, 8
KP_W2L:
    s_and_b32 s11, s11, 0x7000
    s_add_u32 s57, s11, 32768
    s_add_u32 s11, s11, 4096
    s_add_u32 m0, s57, 96768
    s_nop 0
    buffer_load_dwordx4 v5, s[4:7], s57 offen lds
    s_add_u32 s57, s57, 1024
    s_add_u32 m0, s57, 96768
    s_nop 0
    buffer_load_dwordx4 v5, s[4:7], s57 offen lds
    s_add_u32 s57, s57, 1024
    s_add_u32 m0, s57, 96768
    s_nop 0
    buffer_load_dwordx4 v6, s[4:7], s57 offen lds
    s_add_u32 s57, s57, 1024
    s_add_u32 m0, s57, 96768
    s_nop 0
    buffer_load_dwordx4 v6, s[4:7], s57 offen lds
    s_add_u32 s57, s57, 1024
    s_sub_u32 s13, s13, 1
    s_cmp_lg_u32 s13, 0
    s_cbranch_scc1 KP_W2L
    s_waitcnt vmcnt(32)
    s_mov_b32 s56, 0xbfb8aa3b
    v_and_b32 v74, 0xffff0000, v70
    v_lshlrev_b32 v70, 16, v70
    v_and_b32 v75, 0xffff0000, v71
    v_lshlrev_b32 v71, 16, v71
    v_and_b32 v76, 0xffff0000, v72
    v_lshlrev_b32 v72, 16, v72
    v_and_b32 v77, 0xffff0000, v73
    v_lshlrev_b32 v73, 16, v73
    v_mul_f32 v70, s56, v70
    v_mul_f32 v71, s56, v71
    v_mul_f32 v72, s56, v72
    v_mul_f32 v73, s56, v73
    v_mul_f32 v74, s56, v74
    v_mul_f32 v75, s56, v75
    v_mul_f32 v76, s56, v76
    v_mul_f32 v77, s56, v77
    v_cvt_pk_bf16_f32 v20, v70, v71
    v_cvt_pk_bf16_f32 v21, v72, v73
    v_cvt_pk_bf16_f32 v22, v74, v75
    v_cvt_pk_bf16_f32 v23, v76, v77
    v_lshlrev_b32 v12, 4, v127
    ds_write_b128 v12, v[20:23] offset:1024
    s_waitcnt vmcnt(0)
    s_mov_b64 exec, 1
    v_mov_b32 v9, 0x20
    ds_add_u32 v8, v9 offset:208
    s_mov_b64 exec, -1
    s_branch KP_C
K_PST:
    s_cmp_lt_u32 s3, 11
    s_cbranch_scc1 K_PS1
    s_waitcnt vmcnt(0)
    s_mov_b64 exec, 1
    v_mov_b32 v9, 0x100
    ds_add_u32 v8, v9 offset:208
    s_mov_b64 exec, -1
    s_mov_b32 s41, 0
    s_branch KP_C
K_PS1:
    s_sub_u32 s40, s3, 5
    s_lshr_b32 s12, s40, 1
    s_lshl_b32 s56, s12, 12
    s_add_u32 s56, s56, 22528
    s_and_b32 s58, s40, 1
    s_lshl_b32 s58, s58, 7
    v_lshl_add_u32 v114, v123, 8, v3
    v_lshrrev_b32 v1, 2, v123
    v_add_u32 v114, s56, v114
    v_and_b32 v2, 1, v122
    v_lshl_add_u32 v118, v122, 3, v1
    v_lshl_or_b32 v2, v2, 2, v1
    v_xor_b32 v115, 64, v114
    v_xor_b32 v116, 128, v114
    v_xor_b32 v117, 192, v114
    v_lshlrev_b32 v118, 8, v118
    v_lshl_add_u32 v118, v2, 5, v118
    v_and_b32 v1, 3, v127
    v_xor_b32 v118, s58, v118
    v_lshl_add_u32 v118, v1, 3, v118
    v_add_u32 v118, 96768, v118
    v_lshlrev_b32 v124, 10, v122
    v_lshl_add_u32 v124, v123, 3, v124
    s_mul_i32 s13, s62, 10240
    s_lshl_b32 s56, s12, 12
    s_add_u32 s13, s13, s56
    s_add_u32 s13, s13, s58
    s_add_u32 s13, s13, 256
    v_xor_b32 v4, 32, v118
    v_xor_b32 v5, 64, v118
    v_xor_b32 v6, 96, v118
    s_waitcnt vmcnt(0)
    s_mov_b64 exec, 1
    v_mov_b32 v9, 0x100
    ds_add_u32 v8, v9 offset:208
    s_mov_b64 exec, -1
    s_mov_b32 s59, 65536
    s_branch K_SFM5
K_SF4:
    s_sleep 1
K_SFM5:
    ds_read_b32 v27, v8 offset:208
    s_sub_u32 s59, s59, 1
    s_cbranch_scc1 K_END
    s_waitcnt lgkmcnt(0)
    v_readfirstlane_b32 s10, v27
    s_and_b32 s10, s10, 0xf00
    s_cmp_lg_u32 s10, 0x700
    s_cbranch_scc1 K_SF4
    ds_read_b32 v9, v8 offset:192
    ds_read_b128 v[74:77], v114
    ds_read_b64_tr_b16 v[10:11], v118 offset:0
    ds_read_b64_tr_b16 v[12:13], v118 offset:1024
    ds_read_b64_tr_b16 v[26:27], v4 offset:0
    ds_read_b64_tr_b16 v[28:29], v4 offset:1024
    ds_read_b64_tr_b16 v[42:43], v5 offset:0
    ds_read_b64_tr_b16 v[44:45], v5 offset:1024
    ds_read_b64_tr_b16 v[58:59], v6 offset:0
    ds_read_b64_tr_b16 v[60:61], v6 offset:1024
    ds_read_b128 v[78:81], v115
    ds_read_b64_tr_b16 v[14:15], v118 offset:8192
    ds_read_b64_tr_b16 v[16:17], v118 offset:9216
    ds_read_b64_tr_b16 v[30:31], v4 offset:8192
    ds_read_b64_tr_b16 v[32:33], v4 offset:9216
    ds_read_b64_tr_b16 v[46:47], v5 offset:8192
    ds_read_b64_tr_b16 v[48:49], v5 offset:9216
    ds_read_b64_tr_b16 v[62:63], v6 offset:8192
    ds_read_b64_tr_b16 v[64:65], v6 offset:9216
    s_waitcnt lgkmcnt(9)
    v_mfma_f32_16x16x32_bf16 v[90:93], v[74:77], v[10:13], 0
    v_mfma_f32_16x16x32_bf16 v[94:97], v[74:77], v[26:29], 0
    v_mfma_f32_16x16x32_bf16 v[98:101], v[74:77], v[42:45], 0
    v_mfma_f32_16x16x32_bf16 v[102:105], v[74:77], v[58:61], 0
    ds_read_b128 v[82:85], v116
    ds_read_b64_tr_b16 v[18:19], v118 offset:16384
    ds_read_b64_tr_b16 v[20:21], v118 offset:17408
    ds_read_b64_tr_b16 v[34:35], v4 offset:16384
    ds_read_b64_tr_b16 v[36:37], v4 offset:17408
    ds_read_b64_tr_b16 v[50:51], v5 offset:16384
    ds_read_b64_tr_b16 v[52:53], v5 offset:17408
    ds_read_b64_tr_b16 v[66:67], v6 offset:16384
    ds_read_b64_tr_b16 v[68:69], v6 offset:17408
    s_waitcnt lgkmcnt(9)
    v_mfma_f32_16x16x32_bf16 v[90:93], v[78:81], v[14:17], v[90:93]
    v_mfma_f32_16x16x32_bf16 v[94:97], v[78:81], v[30:33], v[94:97]
    v_mfma_f32_16x16x32_bf16 v[98:101], v[78:81], v[46:49], v[98:101]
    v_mfma_f32_16x16x32_bf16 v[102:105], v[78:81], v[62:65], v[102:105]
    ds_read_b128 v[86:89], v117
    ds_read_b64_tr_b16 v[22:23], v118 offset:24576
    ds_read_b64_tr_b16 v[24:25], v118 offset:25600
    ds_read_b64_tr_b16 v[38:39], v4 offset:24576
    ds_read_b64_tr_b16 v[40:41], v4 offset:25600
    ds_read_b64_tr_b16 v[54:55], v5 offset:24576
    ds_read_b64_tr_b16 v[56:57], v5 offset:25600
    ds_read_b64_tr_b16 v[70:71], v6 offset:24576
    ds_read_b64_tr_b16 v[72:73], v6 offset:25600
    s_waitcnt lgkmcnt(9)
    v_mfma_f32_16x16x32_bf16 v[90:93], v[82:85], v[18:21], v[90:93]
    v_mfma_f32_16x16x32_bf16 v[94:97], v[82:85], v[34:37], v[94:97]
    v_mfma_f32_16x16x32_bf16 v[98:101], v[82:85], v[50:53], v[98:101]
    v_mfma_f32_16x16x32_bf16 v[102:105], v[82:85], v[66:69], v[102:105]
    s_waitcnt lgkmcnt(0)
    v_mfma_f32_16x16x32_bf16 v[90:93], v[86:89], v[22:25], v[90:93]
    v_mfma_f32_16x16x32_bf16 v[94:97], v[86:89], v[38:41], v[94:97]
    v_mfma_f32_16x16x32_bf16 v[98:101], v[86:89], v[54:57], v[98:101]
    v_mfma_f32_16x16x32_bf16 v[102:105], v[86:89], v[70:73], v[102:105]
    v_readfirstlane_b32 s10, v9
    s_cmp_lg_u32 s10, 0
    s_cbranch_scc1 K_PS4
    s_mov_b32 s59, 65536
    s_branch K_SPM7
K_SP6:
    s_sleep 1
K_SPM7:
    ds_read_b32 v9, v8 offset:192
    s_sub_u32 s59, s59, 1
    s_cbranch_scc1 K_END
    s_waitcnt lgkmcnt(0)
    v_readfirstlane_b32 s10, v9
    s_cmp_lt_u32 s10, 1
    s_cbranch_scc1 K_SP6
K_PS4:
    s_lshl_b32 s19, s10, 28
    s_lshr_b32 s19, s19, 4
    s_mov_b32 s40, s10
    s_add_u32 s13, s13, s19
    s_mov_b32 s56, 0xbfb8aa3b
    s_mov_b32 s57, 0xbfb8aa3b
    s_cmp_eq_u32 s12, 2
    s_cselect_b32 s11, 0, -1
    s_nop 0
    v_pk_mul_f32 v[90:91], v[90:91], s[56:57]
    v_pk_mul_f32 v[92:93], v[92:93], s[56:57]
    v_pk_mul_f32 v[94:95], v[94:95], s[56:57]
    v_pk_mul_f32 v[96:97], v[96:97], s[56:57]
    v_pk_mul_f32 v[98:99], v[98:99], s[56:57]
    v_pk_mul_f32 v[100:101], v[100:101], s[56:57]
    v_pk_mul_f32 v[102:103], v[102:103], s[56:57]
    v_pk_mul_f32 v[104:105], v[104:105], s[56:57]
    s_mov_b32 exec_hi, s11
    v_cvt_pk_bf16_f32 v106, v90, v94
    v_cvt_pk_bf16_f32 v107, v98, v102
    buffer_store_dwordx2 v[106:107], v124, s[28:31], s13 offen offset:0 sc1
    v_cvt_pk_bf16_f32 v108, v91, v95
    v_cvt_pk_bf16_f32 v109, v99, v103
    buffer_store_dwordx2 v[108:109], v124, s[28:31], s13 offen offset:256 sc1
    v_cvt_pk_bf16_f32 v110, v92, v96
    v_cvt_pk_bf16_f32 v111, v100, v104
    buffer_store_dwordx2 v[110:111], v124, s[28:31], s13 offen offset:512 sc1
    v_cvt_pk_bf16_f32 v112, v93, v97
    v_cvt_pk_bf16_f32 v113, v101, v105
    buffer_store_dwordx2 v[112:113], v124, s[28:31], s13 offen offset:768 sc1
    s_mov_b32 exec_hi, -1
    s_mov_b64 exec, 1
    v_mov_b32 v9, 16
    s_waitcnt vmcnt(0)
    ds_add_u32 v8, v9 offset:196
    s_cmp_eq_u32 s12, 2
    s_cselect_b32 s10, 8, 16
    s_bfm_b32 exec_lo, s10, 0
    v_lshlrev_b32 v2, 8, v127
    buffer_load_dword v2, v2, s[28:31], s13 offen sc1
    s_mov_b64 exec, -1
    s_lshl_b32 s13, s12, 13
    s_add_u32 s13, s13, s58
    s_mov_b32 s57, s40
    v_lshl_add_u32 v114, v122, 11, s13
    v_lshl_add_u32 v114, v7, 8, v114
    v_lshrrev_b32 v1, 1, v123
    v_lshl_add_u32 v114, v1, 4, v114
    s_cmp_eq_u32 s12, 2
    s_cselect_b32 s13, 0xffff, -1
    s_cselect_b32 s11, 0, -1
    s_mov_b32 s59, 65536
    s_branch K_SFM9
K_SF8:
    s_sleep 1
K_SFM9:
    ds_read_b32 v9, v8 offset:208
    s_sub_u32 s59, s59, 1
    s_cbranch_scc1 K_END
    s_waitcnt lgkmcnt(0)
    v_readfirstlane_b32 s10, v9
    s_and_b32 s10, s10, 0xf0
    s_cmp_lg_u32 s10, 0x20
    s_cbranch_scc1 K_SF8
    ds_read_b64_tr_b16 v[10:11], v118 offset:32768
    ds_read_b64_tr_b16 v[12:13], v118 offset:33792
    ds_read_b64_tr_b16 v[26:27], v4 offset:32768
    ds_read_b64_tr_b16 v[28:29], v4 offset:33792
    ds_read_b64_tr_b16 v[42:43], v5 offset:32768
    ds_read_b64_tr_b16 v[44:45], v5 offset:33792
    ds_read_b64_tr_b16 v[58:59], v6 offset:32768
    ds_read_b64_tr_b16 v[60:61], v6 offset:33792
    ds_read_b64_tr_b16 v[14:15], v118 offset:40960
    ds_read_b64_tr_b16 v[16:17], v118 offset:41984
    ds_read_b64_tr_b16 v[30:31], v4 offset:40960
    ds_read_b64_tr_b16 v[32:33], v4 offset:41984
    ds_read_b64_tr_b16 v[46:47], v5 offset:40960
    ds_read_b64_tr_b16 v[48:49], v5 offset:41984
    ds_read_b64_tr_b16 v[62:63], v6 offset:40960
    ds_read_b64_tr_b16 v[64:65], v6 offset:41984
    s_waitcnt lgkmcnt(8)
    v_mfma_f32_16x16x32_bf16 v[90:93], v[74:77], v[10:13], 0
    v_mfma_f32_16x16x32_bf16 v[94:97], v[74:77], v[26:29], 0
    v_mfma_f32_16x16x32_bf16 v[98:101], v[74:77], v[42:45], 0
    v_mfma_f32_16x16x32_bf16 v[102:105], v[74:77], v[58:61], 0
    ds_read_b64_tr_b16 v[18:19], v118 offset:49152
    ds_read_b64_tr_b16 v[20:21], v118 offset:50176
    ds_read_b64_tr_b16 v[34:35], v4 offset:49152
    ds_read_b64_tr_b16 v[36:37], v4 offset:50176
    ds_read_b64_tr_b16 v[50:51], v5 offset:49152
    ds_read_b64_tr_b16 v[52:53], v5 offset:50176
    ds_read_b64_tr_b16 v[66:67], v6 offset:49152
    ds_read_b64_tr_b16 v[68:69], v6 offset:50176
    s_waitcnt lgkmcnt(8)
    v_mfma_f32_16x16x32_bf16 v[90:93], v[78:81], v[14:17], v[90:93]
    v_mfma_f32_16x16x32_bf16 v[94:97], v[78:81], v[30:33], v[94:97]
    v_mfma_f32_16x16x32_bf16 v[98:101], v[78:81], v[46:49], v[98:101]
    v_mfma_f32_16x16x32_bf16 v[102:105], v[78:81], v[62:65], v[102:105]
    ds_read_b64_tr_b16 v[22:23], v118 offset:57344
    ds_read_b64_tr_b16 v[24:25], v118 offset:58368
    ds_read_b64_tr_b16 v[38:39], v4 offset:57344
    ds_read_b64_tr_b16 v[40:41], v4 offset:58368
    ds_read_b64_tr_b16 v[54:55], v5 offset:57344
    ds_read_b64_tr_b16 v[56:57], v5 offset:58368
    ds_read_b64_tr_b16 v[70:71], v6 offset:57344
    ds_read_b64_tr_b16 v[72:73], v6 offset:58368
    s_waitcnt lgkmcnt(8)
    v_mfma_f32_16x16x32_bf16 v[90:93], v[82:85], v[18:21], v[90:93]
    v_mfma_f32_16x16x32_bf16 v[94:97], v[82:85], v[34:37], v[94:97]
    v_mfma_f32_16x16x32_bf16 v[98:101], v[82:85], v[50:53], v[98:101]
    v_mfma_f32_16x16x32_bf16 v[102:105], v[82:85], v[66:69], v[102:105]
    s_waitcnt lgkmcnt(0)
    v_mfma_f32_16x16x32_bf16 v[90:93], v[86:89], v[22:25], v[90:93]
    v_mfma_f32_16x16x32_bf16 v[94:97], v[86:89], v[38:41], v[94:97]
    v_mfma_f32_16x16x32_bf16 v[98:101], v[86:89], v[54:57], v[98:101]
    v_mfma_f32_16x16x32_bf16 v[102:105], v[86:89], v[70:73], v[102:105]
    s_nop 4
    v_mul_f32 v74, s56, v90
    v_mul_f32 v78, s56, v91
    v_mul_f32 v82, s56, v92
    v_mul_f32 v86, s56, v93
    v_mul_f32 v75, s56, v94
    v_mul_f32 v79, s56, v95
    v_mul_f32 v83, s56, v96
    v_mul_f32 v87, s56, v97
    v_mul_f32 v76, s56, v98
    v_mul_f32 v80, s56, v99
    v_mul_f32 v84, s56, v100
    v_mul_f32 v88, s56, v101
    v_mul_f32 v77, s56, v102
    v_mul_f32 v81, s56, v103
    v_mul_f32 v85, s56, v104
    v_mul_f32 v89, s56, v105
    s_mov_b32 exec_hi, s13
    ds_write_b128 v114, v[74:77] offset:34816
    s_mov_b32 exec_hi, s11
    ds_write_b128 v114, v[78:81] offset:35328
    ds_write_b128 v114, v[82:85] offset:35840
    ds_write_b128 v114, v[86:89] offset:36352
    s_mov_b32 exec_hi, -1
    s_mov_b32 s59, 65536
    s_branch K_SPM11
K_SP10:
    s_sleep 1
K_SPM11:
    ds_read_b32 v9, v8 offset:212
    s_sub_u32 s59, s59, 1
    s_cbranch_scc1 K_END
    s_waitcnt lgkmcnt(0)
    v_readfirstlane_b32 s10, v9
    s_cmp_lt_u32 s10, 1
    s_cbranch_scc1 K_SP10
    s_mov_b32 s47, s10
    s_add_u32 s61, s61, s19
    buffer_load_dwordx2 v[108:109], v126, s[28:31], s61 offen sc1
    s_branch KP_C
KP_W2:
    ds_write_b128 v29, v[52:55] offset:3072
    s_waitcnt vmcnt(2)
    v_lshl_or_b32 v40, v40, 16, v16
    v_lshl_or_b32 v41, v41, 16, v17
    v_lshl_or_b32 v42, v42, 16, v18
    v_lshl_or_b32 v43, v43, 16, v19
    ds_read_b32 v56, v32 offset:3072
    ds_read_b32 v57, v33 offset:3072
    ds_read_b32 v58, v34 offset:3072
    ds_read_b32 v59, v35 offset:3072
    s_waitcnt vmcnt(0)
    s_waitcnt lgkmcnt(3)
    v_add_u32 v56, v56, v36
    ds_write_b32 v56, v40 offset:7168
    v_lshlrev_b32 v32, 1, v56
    ds_write_b64 v32, v[20:21] offset:12288
    s_waitcnt lgkmcnt(4)
    v_add_u32 v57, v57, v37
    ds_write_b32 v57, v41 offset:7168
    v_lshlrev_b32 v33, 1, v57
    ds_write_b64 v33, v[22:23] offset:12288
    s_waitcnt lgkmcnt(5)
    v_add_u32 v58, v58, v38
    ds_write_b32 v58, v42 offset:7168
    v_lshlrev_b32 v34, 1, v58
    ds_write_b64 v34, v[24:25] offset:12288
    s_waitcnt lgkmcnt(6)
    v_add_u32 v59, v59, v39
    ds_write_b32 v59, v43 offset:7168
    v_lshlrev_b32 v35, 1, v59
    ds_write_b64 v35, v[26:27] offset:12288
    s_mov_b64 exec, 1
    v_mov_b32 v28, 1
    ds_add_u32 v8, v28 offset:196
    s_mov_b64 exec, -1
    s_mul_i32 s56, s62, 20736
    s_add_u32 s56, s56, 0x280000
    v_add_u32 v11, 5120, v10
    s_mov_b32 s59, 65536
    s_waitcnt lgkmcnt(0)
KP_S2L:
    ds_read_b64 v[48:49], v8 offset:192
    ds_read_b64 v[60:61], v30 offset:12288
    ds_read_b32 v62, v31 offset:7168
    ds_read_b64 v[64:65], v30 offset:14848
    ds_read_b32 v66, v31 offset:8448
    ds_read_b64 v[68:69], v30 offset:17408
    ds_read_b32 v70, v31 offset:9728
    ds_read_b64 v[72:73], v30 offset:19968
    ds_read_b32 v74, v31 offset:11008
    s_sub_u32 s59, s59, 1
    s_cbranch_scc1 K_END
    s_waitcnt lgkmcnt(8)
    v_readfirstlane_b32 s60, v48
    v_readfirstlane_b32 s57, v49
    v_mov_b32 v63, v48
    v_mov_b32 v67, v48
    v_mov_b32 v71, v48
    v_mov_b32 v75, v48
    s_lshl_b32 s19, s60, 28
    s_lshr_b32 s19, s19, 4
    s_add_u32 s12, s56, s19
    s_add_u32 s13, s12, 10240
    s_cmp_lg_u32 s60, 0
    s_cselect_b32 s57, s57, 0
    s_and_b32 s58, s57, 15
    s_cmp_lt_u32 s58, 5
    s_cbranch_scc0 KP_S2K
    s_waitcnt lgkmcnt(0)
    s_sleep 1
    s_branch KP_S2L
KP_S2Q:
    ds_read_b32 v49, v8 offset:196
    s_sub_u32 s59, s59, 1
    s_cbranch_scc1 K_END
    s_waitcnt lgkmcnt(0)
    v_readfirstlane_b32 s57, v49
KP_S2K:
    s_cmp_lt_u32 s57, 101
    s_cbranch_scc1 KP_S2Q
    s_waitcnt lgkmcnt(6)
    buffer_store_dwordx4 v[60:63], v10, s[28:31], s12 offen sc1
    s_waitcnt lgkmcnt(4)
    buffer_store_dwordx4 v[64:67], v11, s[28:31], s12 offen sc1
    s_waitcnt lgkmcnt(2)
    buffer_store_dwordx4 v[68:71], v10, s[28:31], s13 offen sc1
    s_waitcnt lgkmcnt(0)
    buffer_store_dwordx4 v[72:75], v11, s[28:31], s13 offen sc1
    s_setprio 0
    s_branch KP_C
KP_TP:
    s_lshr_b32 s10, s2, 3
    s_lshl_b32 s19, s10, 28
    s_lshr_b32 s19, s19, 4
    v_mul_u32_u24 v109, 0x27c600, v127
    s_mov_b64 exec, 0x1f
    buffer_load_dword v107, v109, s[28:31], s19 offen
    s_mov_b64 exec, -1
KP_C:
    v_mov_b32 v58, 16
    v_lshlrev_b32 v69, 2, v127
    v_and_b32 v104, 7, v127
    v_subrev_u32 v82, 640, v0
    v_cmp_eq_u32 vcc, 0, v104
    v_lshrrev_b32 v82, 3, v82
    v_lshlrev_b32 v81, 9, v82
    v_lshlrev_b32 v80, 6, v104
    v_or_b32 v83, 0x40000, v81
    v_lshl_add_u32 v80, v82, 10, v80
    v_lshlrev_b32 v82, 2, v82
    v_add_u32 v80, 56192, v80
    v_cndmask_b32 v81, v81, v83, vcc
    v_lshlrev_b32 v83, 3, v104
    v_and_b32 v73, 3, v127
    v_cmp_eq_u32 vcc, v73, v122
    v_lshlrev_b32 v70, 3, v122
    v_lshlrev_b32 v71, 1, v127
    v_mov_b32 v73, 0x40000
    v_and_b32 v71, 24, v71
    v_cndmask_b32 v73, v73, 0, vcc
    v_mov_b32 v106, 0
    v_bfe_u32 v55, v127, 2, 2
    v_cmp_eq_u32 vcc, v55, v122
    v_and_b32 v55, 1, v127
    v_lshlrev_b32 v55, 4, v55
    v_mov_b32 v56, 0x3f80
    v_lshlrev_b32 v55, v55, v56
    v_cndmask_b32 v55, 0, v55, vcc
    v_and_b32 v56, 2, v127
    v_cmp_eq_u32 vcc, 0, v56
    v_lshrrev_b32 v53, 3, v127
    s_lshl_b32 s10, s3, 11
    v_lshl_add_u32 v53, v53, 9, s10
    v_lshlrev_b32 v52, 6, v104
    v_lshl_add_u32 v52, v53, 1, v52
    s_lshl_b32 s10, s3, 8
    v_lshl_add_u32 v54, v127, 3, s10
    v_add_u32 v52, 55808, v52
    s_cmp_lt_u32 s3, 10
    s_cselect_b32 exec_lo, -1, 0
    s_mov_b32 exec_hi, 0
    ds_write_b64 v54, v[52:53] offset:4608
    s_mov_b64 exec, -1
    s_sub_u32 s10, s3, 10
    s_lshr_b32 s11, s10, 1
    s_and_b32 s10, s10, 1
    s_lshl_b32 s11, s11, 2
    s_lshr_b32 s11, 0x402, s11
    s_and_b32 s11, s11, 15
    s_add_u32 s10, s10, s11
    s_lshl_b32 s10, s10, 11
    s_add_u32 s10, s10, 117248
    v_lshl_add_u32 v125, v122, 9, s10
    s_mov_b32 s79, 0x40000
    v_cndmask_b32 v32, 0, v55, vcc
    v_cndmask_b32 v33, v55, 0, vcc
    v_mov_b32 v36, v32
    v_mov_b32 v37, v33
    v_mov_b32 v40, v32
    v_mov_b32 v41, v33
    v_mov_b32 v44, v32
    v_mov_b32 v45, v33
    v_mov_b32 v48, v32
    v_mov_b32 v49, v33
    v_lshlrev_b32 v111, 4, v123
    v_lshlrev_b32 v113, 4, v123
    v_lshlrev_b32 v115, 4, v123
    v_lshlrev_b32 v117, 4, v123
    v_lshlrev_b32 v6, 4, v127
    s_mov_b32 s44, 1.0
    s_mov_b32 s45, 1.0
    s_mov_b32 s46, 0x5f800000
    s_mov_b32 s56, 0xbfb8aa3b
    s_mov_b32 s57, 0xbfb8aa3b
    s_mov_b32 s60, 0x3ffff
    s_mov_b32 s63, 0x280000
    s_mov_b32 s40, 0
KP_G:
    s_bitcmp1_b32 s41, 1
    s_cbranch_scc1 KP_T2X
    s_mov_b32 s59, 65536
    s_branch K_SPM13
K_SP12:
    s_sleep 1
K_SPM13:
    ds_read_b32 v9, v8 offset:212
    s_sub_u32 s59, s59, 1
    s_cbranch_scc1 K_END
    s_waitcnt lgkmcnt(0)
    v_readfirstlane_b32 s10, v9
    s_cmp_lt_u32 s10, 1
    s_cbranch_scc1 K_SP12
    s_mov_b32 s47, s10
    s_lshl_b32 s19, s10, 28
    s_lshr_b32 s19, s19, 4
    s_add_u32 s61, s61, s19
    buffer_load_dwordx2 v[108:109], v126, s[28:31], s61 offen sc1
KP_T2X:
    v_cmp_eq_u32 s[68:69], 0, v121
    s_movk_i32 s70, 20464
    s_add_u32 s63, s63, s19
    s_mov_b32 s59, 65536
    s_branch KP_T2W
KP_T2:
    s_sleep 2
    s_mov_b64 exec, vcc
    buffer_load_dwordx2 v[108:109], v126, s[28:31], s61 offen sc1
    s_mov_b64 exec, -1
    s_sub_u32 s59, s59, 1
    s_cbranch_scc1 K_END
KP_T2W:
    s_waitcnt vmcnt(0)
KP_T2V:
    v_cmp_ne_u32 vcc, s47, v109
    s_cbranch_vccnz KP_T2
    v_min_u32_sdwa v109, v108, s70 dst_sel:DWORD dst_unused:UNUSED_PAD src0_sel:WORD_0 src1_sel:DWORD
    v_sub_u32_sdwa v121, v108, v121 dst_sel:DWORD dst_unused:UNUSED_PAD src0_sel:WORD_1 src1_sel:DWORD
    v_add_u32 v120, v120, v109
    v_cmp_lt_i32 s[48:49], 0, v121
    v_cmp_lt_i32 s[50:51], 4, v121
    v_cmp_lt_i32 s[52:53], 8, v121
    v_cmp_lt_i32 s[54:55], 12, v121
    v_cmp_lt_i32 s[14:15], 16, v121
    s_or_b64 s[68:69], s[68:69], s[48:49]
    s_mov_b64 exec, s[68:69]
    buffer_load_dwordx4 v[84:87], v120, s[28:31], s63 offen offset:0 sc1
    s_mov_b64 exec, s[50:51]
    buffer_load_dwordx4 v[88:91], v120, s[28:31], s63 offen offset:64 sc1
    s_mov_b64 exec, s[52:53]
    s_cbranch_execz K2_RL14
    buffer_load_dwordx4 v[92:95], v120, s[28:31], s63 offen offset:128 sc1
    s_mov_b64 exec, s[54:55]
    s_cbranch_execz K2_RL14
    buffer_load_dwordx4 v[96:99], v120, s[28:31], s63 offen offset:192 sc1
    s_mov_b64 exec, s[14:15]
    s_cbranch_execz K2_RL14
    buffer_load_dwordx4 v[100:103], v120, s[28:31], s63 offen offset:256 sc1
K2_RL14:
    s_mov_b64 exec, -1
    s_cmp_ge_u32 s3, 8
    s_cbranch_scc1 K2_NOF0
    v_and_b32 v79, 3, v127
    s_add_u32 s10, s19, 0x810000
    v_lshlrev_b32 v79, 6, v79
    buffer_load_dword v79, v79, s[28:31], s10 offen sc1
K2_NOF0:
    ds_write_b32 v119, v108
    s_mov_b32 s10, 65536
K2_B3:
    ds_read_b32 v27, v8 offset:208
    ds_read_b128 v[28:31], v6 offset:1024
    s_sub_u32 s10, s10, 1
    s_cbranch_scc1 K_END
    s_waitcnt lgkmcnt(0)
    v_readfirstlane_b32 s11, v27
    s_bitcmp0_b32 s11, 5
    s_cbranch_scc1 K2_B3
    v_mov_b32 v0, v28
    v_mov_b32 v1, v29
    v_mov_b32 v6, v30
    v_mov_b32 v7, v31
    v_mov_b32 v8, v28
    v_mov_b32 v9, v29
    v_mov_b32 v14, v30
    v_mov_b32 v15, v31
    v_mov_b32 v16, v28
    v_mov_b32 v17, v29
    v_mov_b32 v22, v30
    v_mov_b32 v23, v31
    v_mov_b32 v24, v28
    v_mov_b32 v25, v29
K2_LATER:
    s_cmp_ge_u32 s3, 10
    s_cbranch_scc1 K2_LAT2
    s_lshl_b32 s76, s3, 8
    s_add_u32 s76, s76, 4608
    s_mov_b32 s77, 8
    s_lshl_b32 s11, s3, 11
    s_mov_b32 s12, 55808
    s_lshl1_add_u32 s13, s11, s12
    v_lshl_add_u32 v119, v70, 6, s11
    v_lshl_add_u32 v75, v71, 7, s13
    v_lshl_add_u32 v72, v119, 1, s12
    v_add_u32 v75, v75, v73
    v_or_b32 v76, v119, v111
    v_lshrrev_b32 v77, 7, v119
    v_add_u32 v74, 64, v72
    v_add_u32 v118, 128, v72
    v_add_u32 v124, 64, v75
    s_mov_b32 s43, 6
K2_LAT2:
    s_mov_b32 s10, 65536
    s_waitcnt vmcnt(0)
    s_branch K2_RECW2
K2_RETRY:
    s_sleep 4
    s_mov_b64 exec, s[4:5]
    buffer_load_dwordx4 v[84:87], v120, s[28:31], s63 offen offset:0 sc1
    s_mov_b64 exec, s[6:7]
    buffer_load_dwordx4 v[88:91], v120, s[28:31], s63 offen offset:64 sc1
    s_mov_b64 exec, s[8:9]
    buffer_load_dwordx4 v[92:95], v120, s[28:31], s63 offen offset:128 sc1
    s_mov_b64 exec, s[16:17]
    buffer_load_dwordx4 v[96:99], v120, s[28:31], s63 offen offset:192 sc1
    s_mov_b64 exec, vcc
    buffer_load_dwordx4 v[100:103], v120, s[28:31], s63 offen offset:256 sc1
K2_RECW:
    s_waitcnt vmcnt(0)
K2_RECW2:
    s_mov_b64 exec, s[68:69]
    v_cmp_ne_u32 s[4:5], s47, v87
    v_lshrrev_b32 v59, 14, v86
    s_mov_b64 exec, s[50:51]
    v_cmp_ne_u32 s[6:7], s47, v91
    v_lshrrev_b32 v60, 14, v90
    s_mov_b64 exec, s[52:53]
    v_cmp_ne_u32 s[8:9], s47, v95
    v_lshrrev_b32 v61, 14, v94
    s_mov_b64 exec, s[54:55]
    v_cmp_ne_u32 s[16:17], s47, v99
    v_lshrrev_b32 v62, 14, v98
    s_mov_b64 exec, s[14:15]
    v_cmp_ne_u32 vcc, s47, v103
    v_lshrrev_b32 v63, 14, v102
    s_mov_b64 exec, -1
    s_or_b64 s[12:13], s[4:5], s[6:7]
    s_or_b64 s[22:23], s[8:9], s[16:17]
    s_or_b64 s[12:13], s[12:13], s[22:23]
    s_sub_u32 s10, s10, 1
    s_cbranch_scc1 K_END
    s_or_b64 s[12:13], vcc, s[12:13]
    s_cbranch_scc1 K2_RETRY
    s_lshr_b32 s12, s2, 3
    s_mul_i32 s12, s12, 81920
    s_mul_i32 s13, s3, 5120
    v_lshlrev_b32 v109, 7, v127
    s_add_u32 s12, s12, s13
    s_add_u32 s12, s12, s19
    s_mov_b64 exec, 0xff
    buffer_load_dword v2, v109, s[28:31], s12 offen offset:256 sc1
    s_mov_b64 exec, -1
    s_movk_i32 s10, 0x400
    s_mov_b64 exec, s[48:49]
    ds_add_rtn_u32 v64, v59, v58 offset:256
    s_mov_b64 exec, s[50:51]
    ds_add_rtn_u32 v65, v60, v58 offset:256
    s_mov_b64 exec, s[52:53]
    ds_add_rtn_u32 v66, v61, v58 offset:256
    s_mov_b64 exec, s[48:49]
    s_waitcnt lgkmcnt(2)
    v_cmpx_gt_u32 vcc, s10, v64
    v_lshl_add_u32 v59, v59, 8, v64
    ds_write_b96 v59, v[84:86] offset:55808
    s_andn2_b64 s[48:49], s[48:49], exec
    s_mov_b64 exec, s[50:51]
    s_waitcnt lgkmcnt(2)
    v_cmpx_gt_u32 vcc, s10, v65
    v_lshl_add_u32 v60, v60, 8, v65
    ds_write_b96 v60, v[88:90] offset:55808
    s_andn2_b64 s[50:51], s[50:51], exec
    s_mov_b64 exec, s[52:53]
    s_waitcnt lgkmcnt(2)
    v_cmpx_gt_u32 vcc, s10, v66
    v_lshl_add_u32 v61, v61, 8, v66
    ds_write_b96 v61, v[92:94] offset:55808
    s_andn2_b64 s[52:53], s[52:53], exec
    s_or_b64 s[6:7], s[54:55], s[14:15]
    s_cbranch_scc0 K2_PL2
    s_waitcnt lgkmcnt(0)
    s_mov_b64 exec, s[54:55]
    ds_add_rtn_u32 v67, v62, v58 offset:256
    s_mov_b64 exec, s[14:15]
    ds_add_rtn_u32 v68, v63, v58 offset:256
    s_mov_b64 exec, s[54:55]
    s_waitcnt lgkmcnt(1)
    v_cmpx_gt_u32 vcc, s10, v67
    v_lshl_add_u32 v62, v62, 8, v67
    ds_write_b96 v62, v[96:98] offset:55808
    s_andn2_b64 s[54:55], s[54:55], exec
    s_mov_b64 exec, s[14:15]
    s_waitcnt lgkmcnt(1)
    v_cmpx_gt_u32 vcc, s10, v68
    v_lshl_add_u32 v63, v63, 8, v68
    ds_write_b96 v63, v[100:102] offset:55808
    s_andn2_b64 s[14:15], s[14:15], exec
    s_or_b64 s[6:7], s[54:55], s[14:15]
K2_PL2:
    s_mov_b64 exec, -1
    v_cmp_lt_i32 vcc, 20, v121
    s_or_b64 s[4:5], s[48:49], s[50:51]
    s_or_b64 s[6:7], s[6:7], s[52:53]
    s_or_b64 s[4:5], s[4:5], s[6:7]
    s_or_b64 vcc, vcc, s[4:5]
    s_cbranch_vccz K2_NOMORE
    v_mov_b32 v64, 1
    v_mov_b32 v65, 508
    ds_write_b32 v65, v64
K2_NOMORE:
    v_mov_b32 v121, v76
    v_add_u32 v120, 96768, v76
    v_cmp_ne_u32 vcc, s47, v79
    v_add_u32 v76, s79, v120
    s_cmp_lt_u32 s3, 8
    s_cselect_b32 s74, s79, 0
    s_cmp_eq_u32 s74, 0
    s_cbranch_scc1 K2_NWF
    v_lshlrev_b32 v83, 4, v127
    s_mov_b32 s74, 2
    s_cbranch_vccnz K2_NWF
    s_mov_b32 s74, 1
    s_lshl_b32 s10, s3, 12
    s_add_u32 s10, s10, 0x820000
    s_add_u32 s10, s10, s19
    buffer_load_dwordx4 v[84:87], v83, s[28:31], s10 offen offset:0 sc1
    buffer_load_dwordx4 v[88:91], v83, s[28:31], s10 offen offset:1024 sc1
    buffer_load_dwordx4 v[92:95], v83, s[28:31], s10 offen offset:2048 sc1
    buffer_load_dwordx4 v[96:99], v83, s[28:31], s10 offen offset:3072 sc1
K2_NWF:
    s_cmp_ge_u32 s3, 10
    s_waitcnt lgkmcnt(0)
    s_barrier
    s_setprio 3
    s_cbranch_scc1 K2_REM
    ds_read_u16 v110, v72 offset:8
    ds_read_u16 v112, v72 offset:24
    ds_read_u16 v114, v72 offset:40
    ds_read_u16 v116, v72 offset:56
    ds_read_b32 v78, v77 offset:256
    ds_read_b32 v79, v106 offset:508
    ds_read_b128 v[50:53], v121 offset:34816
    ds_read_b128 v[54:57], v121 offset:35072
    ds_read_b128 v[102:105], v76
    ds_read_b128 v[106:109], v76 offset:256
    s_waitcnt lgkmcnt(6)
    buffer_load_dwordx4 v[2:5], v[110:111], s[32:35], s19 idxen offen sc1
    buffer_load_dwordx4 v[10:13], v[112:113], s[32:35], s19 idxen offen sc1
    buffer_load_dwordx4 v[18:21], v[114:115], s[32:35], s19 idxen offen sc1
    buffer_load_dwordx4 v[26:29], v[116:117], s[32:35], s19 idxen offen sc1
    ds_read_b64 v[34:35], v75 offset:0
    ds_read_b64 v[38:39], v75 offset:16
    ds_read_b64 v[42:43], v75 offset:32
    ds_read_b64 v[46:47], v75 offset:48
    ds_read_u16 v110, v74 offset:8
    ds_read_u16 v112, v74 offset:24
    ds_read_u16 v114, v74 offset:40
    ds_read_u16 v116, v74 offset:56
    s_waitcnt lgkmcnt(8)
    v_readfirstlane_b32 s41, v79
    s_cmp_eq_u32 s41, 0
    s_cselect_b32 s25, s79, 0
    s_cmp_lg_u32 s25, 0
    s_cselect_b32 s24, 16, 48
    s_cselect_b32 s25, 5, 6
    s_lshl_b32 s25, -1, s25
    s_cmp_eq_u32 s79, 0
    s_cbranch_scc1 K2_SKIP
K2_CORR:
    v_exp_f32 v58, v50
    v_exp_f32 v59, v51
    v_exp_f32 v60, v52
    v_exp_f32 v61, v53
    v_exp_f32 v62, v54
    v_exp_f32 v63, v55
    v_exp_f32 v64, v56
    v_exp_f32 v65, v57
    v_min_u32 v78, 0x400, v78
    v_add_u32 v75, s24, v78
    v_and_b32 v75, s25, v75
    v_max_u32 v75, 384, v75
    v_sub_u32 v78, v75, v78
    v_pk_add_f32 v[58:59], v[58:59], s[44:45]
    v_pk_add_f32 v[60:61], v[60:61], s[44:45]
    v_pk_add_f32 v[62:63], v[62:63], s[44:45]
    v_pk_add_f32 v[64:65], v[64:65], s[44:45]
    v_cvt_f32_u32 v78, v78
    v_rcp_f32 v58, v58
    v_rcp_f32 v59, v59
    v_rcp_f32 v60, v60
    v_rcp_f32 v61, v61
    v_rcp_f32 v62, v62
    v_rcp_f32 v63, v63
    v_rcp_f32 v64, v64
    v_rcp_f32 v65, v65
    v_mul_f32 v78, 0xbd800000, v78
    v_pk_mul_f32 v[58:59], v[50:51], v[58:59]
    v_pk_mul_f32 v[60:61], v[52:53], v[60:61]
    v_pk_mul_f32 v[62:63], v[54:55], v[62:63]
    v_pk_mul_f32 v[64:65], v[56:57], v[64:65]
    v_pk_fma_f32 v[102:103], v[58:59], v[78:79], v[102:103] op_sel_hi:[1,0,1]
    v_pk_fma_f32 v[104:105], v[60:61], v[78:79], v[104:105] op_sel_hi:[1,0,1]
    v_pk_fma_f32 v[106:107], v[62:63], v[78:79], v[106:107] op_sel_hi:[1,0,1]
    v_pk_fma_f32 v[108:109], v[64:65], v[78:79], v[108:109] op_sel_hi:[1,0,1]
    s_cmp_lt_u32 s74, 1
    s_cbranch_scc1 K2_OGO
    v_lshlrev_b32 v82, 1, v70
    v_xor_b32 v82, v82, v111
    v_lshl_add_u32 v82, v111, 4, v82
    v_xor_b32 v100, 64, v82
    v_xor_b32 v101, 128, v82
    v_xor_b32 v126, 192, v82
    ds_read_b128 v[58:61], v82 offset:22528
    ds_read_b128 v[62:65], v100 offset:22528
    ds_read_b128 v[66:69], v101 offset:22528
    ds_read_b128 v[70:73], v126 offset:22528
    s_cmp_eq_u32 s74, 2
    s_cbranch_scc1 K2_WFL
    s_waitcnt vmcnt(4)
K2_WFD:
    s_mul_i32 s10, s3, 3072
    s_cmp_lt_u32 s3, 5
    s_cselect_b32 s11, 0, 127488
    s_add_u32 s10, s10, s11
    v_add_u32 v83, s10, v83
    s_waitcnt lgkmcnt(3)
    v_mfma_f32_16x16x32_bf16 v[74:77], v[84:87], v[58:61], 0
    ds_read_b128 v[58:61], v82 offset:26624
    s_waitcnt lgkmcnt(3)
    v_mfma_f32_16x16x32_bf16 v[74:77], v[88:91], v[62:65], v[74:77]
    ds_read_b128 v[62:65], v100 offset:26624
    s_waitcnt lgkmcnt(3)
    v_mfma_f32_16x16x32_bf16 v[74:77], v[92:95], v[66:69], v[74:77]
    ds_read_b128 v[66:69], v101 offset:26624
    s_waitcnt lgkmcnt(3)
    v_mfma_f32_16x16x32_bf16 v[74:77], v[96:99], v[70:73], v[74:77]
    ds_read_b128 v[70:73], v126 offset:26624
    s_waitcnt lgkmcnt(3)
    v_mfma_f32_16x16x32_bf16 v[78:81], v[84:87], v[58:61], 0
    ds_read_b128 v[58:61], v82 offset:30720
    s_waitcnt lgkmcnt(3)
    v_mfma_f32_16x16x32_bf16 v[78:81], v[88:91], v[62:65], v[78:81]
    ds_read_b128 v[62:65], v100 offset:30720
    s_waitcnt lgkmcnt(3)
    v_mfma_f32_16x16x32_bf16 v[78:81], v[92:95], v[66:69], v[78:81]
    ds_read_b128 v[66:69], v101 offset:30720
    s_waitcnt lgkmcnt(3)
    v_mfma_f32_16x16x32_bf16 v[78:81], v[96:99], v[70:73], v[78:81]
    ds_read_b128 v[70:73], v126 offset:30720
    ds_write_b128 v83, v[74:77] offset:7168
    s_waitcnt lgkmcnt(4)
    v_mfma_f32_16x16x32_bf16 v[74:77], v[84:87], v[58:61], 0
    s_waitcnt lgkmcnt(3)
    v_mfma_f32_16x16x32_bf16 v[74:77], v[88:91], v[62:65], v[74:77]
    s_waitcnt lgkmcnt(2)
    v_mfma_f32_16x16x32_bf16 v[74:77], v[92:95], v[66:69], v[74:77]
    s_waitcnt lgkmcnt(1)
    v_mfma_f32_16x16x32_bf16 v[74:77], v[96:99], v[70:73], v[74:77]
    ds_write_b128 v83, v[78:81] offset:8192
    s_nop 7
    ds_write_b128 v83, v[74:77] offset:9216
K2_OGO:
    s_mov_b32 s18, s43
    s_mov_b32 s72, 64
    s_mov_b32 s73, 64
    v_mov_b32 v119, v124
    v_pk_add_f32 v[120:121], s[44:45], 0
    v_pk_add_f32 v[122:123], s[44:45], 0
    v_pk_add_f32 v[124:125], s[44:45], 0
    v_pk_add_f32 v[126:127], s[44:45], 0
    s_waitcnt vmcnt(0) lgkmcnt(0)
    v_mfma_f32_16x16x32_bf16 v[58:61], v[34:37], v[0:3], v[50:53]
    v_mfma_f32_16x16x32_bf16 v[62:65], v[38:41], v[8:11], v[50:53]
    v_mfma_f32_16x16x32_bf16 v[66:69], v[42:45], v[16:19], v[50:53]
    v_mfma_f32_16x16x32_bf16 v[70:73], v[46:49], v[24:27], v[50:53]
    s_nop 7
.p2align 6
K2_OLOOP:
    s_cmp_eq_u32 s43, 1
    v_exp_f32 v90, v58
    v_mfma_f32_16x16x32_bf16 v[74:77], v[32:35], v[4:7], v[54:57]
    v_exp_f32 v91, v59
    v_exp_f32 v92, v60
    v_mfma_f32_16x16x32_bf16 v[78:81], v[36:39], v[12:15], v[54:57]
    v_exp_f32 v93, v61
    v_exp_f32 v94, v62
    v_mfma_f32_16x16x32_bf16 v[82:85], v[40:43], v[20:23], v[54:57]
    v_exp_f32 v95, v63
    v_exp_f32 v96, v64
    v_mfma_f32_16x16x32_bf16 v[86:89], v[44:47], v[28:31], v[54:57]
    v_exp_f32 v97, v65
    s_cbranch_scc1 K2_NL15
    s_waitcnt lgkmcnt(0)
    buffer_load_dwordx4 v[2:5], v[110:111], s[32:35], s19 idxen offen sc1
    buffer_load_dwordx4 v[10:13], v[112:113], s[32:35], s19 idxen offen sc1
    buffer_load_dwordx4 v[18:21], v[114:115], s[32:35], s19 idxen offen sc1
    buffer_load_dwordx4 v[26:29], v[116:117], s[32:35], s19 idxen offen sc1
    ds_read_b64 v[34:35], v119 offset:0
    ds_read_b64 v[38:39], v119 offset:16
    ds_read_b64 v[42:43], v119 offset:32
    ds_read_b64 v[46:47], v119 offset:48
    ds_read_u16 v110, v118 offset:8
    ds_read_u16 v112, v118 offset:24
    ds_read_u16 v114, v118 offset:40
    ds_read_u16 v116, v118 offset:56
    v_lshl_add_u64 v[118:119], v[118:119], 0, s[72:73]
K2_NL15:
    v_exp_f32 v98, v66
    v_exp_f32 v99, v67
    v_exp_f32 v100, v68
    v_exp_f32 v101, v69
    v_pk_fma_f32 v[102:103], v[102:103], v[90:91], v[102:103]
    v_pk_fma_f32 v[104:105], v[104:105], v[92:93], v[104:105]
    v_pk_fma_f32 v[102:103], v[58:59], v[120:121], v[102:103]
    v_pk_fma_f32 v[104:105], v[60:61], v[122:123], v[104:105]
    v_pk_fma_f32 v[120:121], v[120:121], v[90:91], v[120:121]
    v_pk_fma_f32 v[122:123], v[122:123], v[92:93], v[122:123]
    v_exp_f32 v90, v70
    v_exp_f32 v91, v71
    v_exp_f32 v92, v72
    v_exp_f32 v93, v73
    v_pk_fma_f32 v[102:103], v[102:103], v[94:95], v[102:103]
    v_pk_fma_f32 v[104:105], v[104:105], v[96:97], v[104:105]
    v_pk_fma_f32 v[102:103], v[62:63], v[120:121], v[102:103]
    v_pk_fma_f32 v[104:105], v[64:65], v[122:123], v[104:105]
    v_pk_fma_f32 v[120:121], v[120:121], v[94:95], v[120:121]
    v_pk_fma_f32 v[122:123], v[122:123], v[96:97], v[122:123]
    v_pk_fma_f32 v[102:103], v[102:103], v[98:99], v[102:103]
    v_pk_fma_f32 v[104:105], v[104:105], v[100:101], v[104:105]
    v_pk_fma_f32 v[102:103], v[66:67], v[120:121], v[102:103]
    v_pk_fma_f32 v[104:105], v[68:69], v[122:123], v[104:105]
    v_pk_fma_f32 v[120:121], v[120:121], v[98:99], v[120:121]
    v_pk_fma_f32 v[122:123], v[122:123], v[100:101], v[122:123]
    v_pk_fma_f32 v[102:103], v[102:103], v[90:91], v[102:103]
    v_pk_fma_f32 v[104:105], v[104:105], v[92:93], v[104:105]
    v_pk_fma_f32 v[102:103], v[70:71], v[120:121], v[102:103]
    v_pk_fma_f32 v[104:105], v[72:73], v[122:123], v[104:105]
    v_pk_fma_f32 v[120:121], v[120:121], v[90:91], v[120:121]
    v_pk_fma_f32 v[122:123], v[122:123], v[92:93], v[122:123]
    s_cbranch_scc1 K2_OLOOPT
    v_exp_f32 v90, v74
    s_waitcnt vmcnt(3) lgkmcnt(0)
    v_mfma_f32_16x16x32_bf16 v[58:61], v[34:37], v[0:3], v[50:53]
    v_exp_f32 v91, v75
    v_exp_f32 v92, v76
    s_waitcnt vmcnt(2)
    v_mfma_f32_16x16x32_bf16 v[62:65], v[38:41], v[8:11], v[50:53]
    v_exp_f32 v93, v77
    v_exp_f32 v94, v78
    s_waitcnt vmcnt(1)
    v_mfma_f32_16x16x32_bf16 v[66:69], v[42:45], v[16:19], v[50:53]
    v_exp_f32 v95, v79
    v_exp_f32 v96, v80
    s_waitcnt vmcnt(0)
    v_mfma_f32_16x16x32_bf16 v[70:73], v[46:49], v[24:27], v[50:53]
    v_exp_f32 v97, v81
    v_exp_f32 v98, v82
    v_exp_f32 v99, v83
    v_exp_f32 v100, v84
    v_exp_f32 v101, v85
    v_pk_fma_f32 v[106:107], v[106:107], v[90:91], v[106:107]
    v_pk_fma_f32 v[108:109], v[108:109], v[92:93], v[108:109]
    v_pk_fma_f32 v[106:107], v[74:75], v[124:125], v[106:107]
    v_pk_fma_f32 v[108:109], v[76:77], v[126:127], v[108:109]
    v_pk_fma_f32 v[124:125], v[124:125], v[90:91], v[124:125]
    v_pk_fma_f32 v[126:127], v[126:127], v[92:93], v[126:127]
    v_exp_f32 v90, v86
    v_exp_f32 v91, v87
    v_exp_f32 v92, v88
    v_exp_f32 v93, v89
    v_pk_fma_f32 v[106:107], v[106:107], v[94:95], v[106:107]
    v_pk_fma_f32 v[108:109], v[108:109], v[96:97], v[108:109]
    v_pk_fma_f32 v[106:107], v[78:79], v[124:125], v[106:107]
    v_pk_fma_f32 v[108:109], v[80:81], v[126:127], v[108:109]
    v_pk_fma_f32 v[124:125], v[124:125], v[94:95], v[124:125]
    v_pk_fma_f32 v[126:127], v[126:127], v[96:97], v[126:127]
    v_pk_fma_f32 v[106:107], v[106:107], v[98:99], v[106:107]
    v_pk_fma_f32 v[108:109], v[108:109], v[100:101], v[108:109]
    v_pk_fma_f32 v[106:107], v[82:83], v[124:125], v[106:107]
    v_pk_fma_f32 v[108:109], v[84:85], v[126:127], v[108:109]
    v_pk_fma_f32 v[124:125], v[124:125], v[98:99], v[124:125]
    v_pk_fma_f32 v[126:127], v[126:127], v[100:101], v[126:127]
    v_pk_fma_f32 v[106:107], v[106:107], v[90:91], v[106:107]
    v_pk_fma_f32 v[108:109], v[108:109], v[92:93], v[108:109]
    v_pk_fma_f32 v[106:107], v[86:87], v[124:125], v[106:107]
    v_pk_fma_f32 v[108:109], v[88:89], v[126:127], v[108:109]
    v_pk_fma_f32 v[124:125], v[124:125], v[90:91], v[124:125]
    v_pk_fma_f32 v[126:127], v[126:127], v[92:93], v[126:127]
    s_sub_u32 s43, s43, 1
    s_cmp_gt_u32 s43, 2
    s_cbranch_scc1 K2_OLOOP
    s_setprio 2
    s_cmp_eq_u32 s43, 2
    s_cbranch_scc1 K2_OLOOP
    s_setprio 1
    s_branch K2_OLOOP
K2_OLOOPT:
    s_setprio 1
    v_subrev_u32 v119, 56256, v118
    v_lshrrev_b32 v119, 1, v119
    v_lshrrev_b32 v110, 1, v119
    v_mov_b32 v116, 0
    v_lshrrev_b32 v112, 5, v119
    s_mul_i32 s12, s3, 3072
    s_add_u32 s12, s12, 0x828000
    v_add_u32 v110, v110, v111
    s_add_u32 s12, s12, s19
    s_cmp_ge_u32 s3, 8
    ds_read_b32 v114, v116 offset:224
    ds_read_b128 v[70:73], v112 offset:512
    s_cbranch_scc1 K2_NW216
    buffer_load_dwordx4 v[2:5], v110, s[28:31], s12 offen offset:0 sc1
    buffer_load_dwordx4 v[10:13], v110, s[28:31], s12 offen offset:1024 sc1
    buffer_load_dwordx4 v[18:21], v110, s[28:31], s12 offen offset:2048 sc1
    buffer_load_dwordx4 v[26:29], v110, s[28:31], s12 offen offset:3072 sc1
K2_NW216:
    v_exp_f32 v90, v74
    v_exp_f32 v91, v75
    v_exp_f32 v92, v76
    v_exp_f32 v93, v77
    v_exp_f32 v94, v78
    v_exp_f32 v95, v79
    v_exp_f32 v96, v80
    v_exp_f32 v97, v81
    s_cmp_eq_u32 s41, 0
    s_cselect_b32 s11, 6, -1
    s_waitcnt lgkmcnt(0)
    v_readfirstlane_b32 s75, v114
    s_sub_u32 s75, s75, s11
    s_cmp_lg_u32 s75, 0
    s_cbranch_scc1 K2_NOPRE
    s_mov_b32 s13, 96768
    v_add3_u32 v116, v119, v111, s13
    v_add_u32 v42, v70, v111
    v_add_u32 v43, v71, v111
    v_add_u32 v118, v72, v116
    v_cmp_lt_i32 vcc, 2, v73
    ds_read_b128 v[58:61], v42 offset:0
    ds_read_b128 v[62:65], v42 offset:256
    ds_read_b128 v[66:69], v43 offset:512
    ds_read_b128 v[70:73], v43 offset:768
    ds_read_b128 v[50:53], v118
    ds_read_b128 v[54:57], v118 offset:256
K2_NOPRE:
    v_exp_f32 v98, v82
    v_exp_f32 v99, v83
    v_exp_f32 v100, v84
    v_exp_f32 v101, v85
    v_pk_fma_f32 v[106:107], v[106:107], v[90:91], v[106:107]
    v_pk_fma_f32 v[108:109], v[108:109], v[92:93], v[108:109]
    v_pk_fma_f32 v[106:107], v[74:75], v[124:125], v[106:107]
    v_pk_fma_f32 v[108:109], v[76:77], v[126:127], v[108:109]
    v_pk_fma_f32 v[124:125], v[124:125], v[90:91], v[124:125]
    v_pk_fma_f32 v[126:127], v[126:127], v[92:93], v[126:127]
    v_exp_f32 v90, v86
    v_exp_f32 v91, v87
    v_exp_f32 v92, v88
    v_exp_f32 v93, v89
    v_pk_fma_f32 v[106:107], v[106:107], v[94:95], v[106:107]
    v_pk_fma_f32 v[108:109], v[108:109], v[96:97], v[108:109]
    v_pk_fma_f32 v[106:107], v[78:79], v[124:125], v[106:107]
    v_pk_fma_f32 v[108:109], v[80:81], v[126:127], v[108:109]
    v_pk_fma_f32 v[124:125], v[124:125], v[94:95], v[124:125]
    v_pk_fma_f32 v[126:127], v[126:127], v[96:97], v[126:127]
    v_pk_fma_f32 v[106:107], v[106:107], v[98:99], v[106:107]
    v_pk_fma_f32 v[108:109], v[108:109], v[100:101], v[108:109]
    v_pk_fma_f32 v[106:107], v[82:83], v[124:125], v[106:107]
    v_pk_fma_f32 v[108:109], v[84:85], v[126:127], v[108:109]
    v_pk_fma_f32 v[124:125], v[124:125], v[98:99], v[124:125]
    v_pk_fma_f32 v[126:127], v[126:127], v[100:101], v[126:127]
    v_pk_fma_f32 v[106:107], v[106:107], v[90:91], v[106:107]
    v_pk_fma_f32 v[108:109], v[108:109], v[92:93], v[108:109]
    v_pk_fma_f32 v[106:107], v[86:87], v[124:125], v[106:107]
    v_pk_fma_f32 v[108:109], v[88:89], v[126:127], v[108:109]
    v_pk_fma_f32 v[124:125], v[124:125], v[90:91], v[124:125]
    v_pk_fma_f32 v[126:127], v[126:127], v[92:93], v[126:127]
    s_setprio 0
    v_rcp_f32 v90, v120
    v_rcp_f32 v91, v121
    v_rcp_f32 v92, v122
    v_rcp_f32 v93, v123
    v_rcp_f32 v94, v124
    v_rcp_f32 v95, v125
    v_rcp_f32 v96, v126
    v_rcp_f32 v97, v127
    v_pk_add_f32 v[46:47], v[120:121], v[122:123]
    v_pk_add_f32 v[38:39], v[124:125], v[126:127]
    s_mov_b32 s8, 0x6c800000
    v_pk_add_f32 v[46:47], v[46:47], v[38:39]
    v_cmp_nge_f32 s[4:5], s8, v46
    v_cmp_nge_f32 s[6:7], s8, v47
    s_or_b64 s[4:5], s[4:5], s[6:7]
    s_cbranch_scc1 K2_REDO
    s_cmp_lg_u32 s75, 0
    s_cbranch_scc1 K2_OWAIT
K2_OFAST:
    s_mul_i32 s10, s3, 3072
    s_cmp_lt_u32 s3, 5
    s_cselect_b32 s11, 0, 127488
    s_add_u32 s10, s10, s11
    s_lshl_b32 s11, s3, 10
    s_sub_u32 s10, s10, s11
    v_add_u32 v17, s10, v110
    s_movk_i32 s12, 0xf0
    s_mov_b32 s58, 0xbf317218
    s_mov_b32 s59, 0xbf317218
    s_cmp_ge_u32 s3, 8
    s_waitcnt lgkmcnt(0)
    s_cbranch_scc1 K2_EPI_A
    ds_read_b128 v[78:81], v17 offset:7168
    ds_read_b128 v[82:85], v17 offset:8192
    ds_read_b128 v[86:89], v17 offset:9216
K2_EPI_A:
    v_pk_add_f32 v[58:59], v[58:59], v[66:67]
    v_pk_add_f32 v[60:61], v[60:61], v[68:69]
    v_pk_add_f32 v[62:63], v[62:63], v[70:71]
    v_pk_add_f32 v[64:65], v[64:65], v[72:73]
    v_pk_add_f32 v[58:59], v[58:59], v[50:51]
    v_pk_add_f32 v[60:61], v[60:61], v[52:53]
    v_pk_add_f32 v[62:63], v[62:63], v[54:55]
    v_pk_add_f32 v[64:65], v[64:65], v[56:57]
    v_bitop3_b32 v116, v116, v112, s12 bitop3:0x78
    v_pk_fma_f32 v[102:103], v[102:103], v[90:91], v[58:59]
    v_pk_fma_f32 v[104:105], v[104:105], v[92:93], v[60:61]
    v_pk_fma_f32 v[106:107], v[106:107], v[94:95], v[62:63]
    v_pk_fma_f32 v[108:109], v[108:109], v[96:97], v[64:65]
    s_cbranch_vccnz K2_MORESL
K2_EPI_B:
    v_pk_mul_f32 v[102:103], v[102:103], s[58:59]
    v_pk_mul_f32 v[104:105], v[104:105], s[58:59]
    v_pk_mul_f32 v[106:107], v[106:107], s[58:59]
    v_pk_mul_f32 v[108:109], v[108:109], s[58:59]
    v_cvt_pk_bf16_f32 v90, v102, v103
    v_cvt_pk_bf16_f32 v91, v104, v105
    v_cvt_pk_bf16_f32 v92, v106, v107
    v_cvt_pk_bf16_f32 v93, v108, v109
    ds_write_b128 v116, v[90:93]
    s_mov_b32 s10, 72192
    v_add3_u32 v16, v110, v112, s10
    v_lshrrev_b32 v17, 4, v110
    v_and_b32 v17, 48, v17
    v_mul_u32_u24 v14, 17, v111
    v_xor_b32 v6, v17, v111
    v_lshrrev_b32 v17, 1, v17
    v_lshl_add_u32 v6, v111, 5, v6
    s_lshl_b32 s11, s3, 5
    s_add_u32 s10, s10, s11
    v_lshrrev_b32 v15, 7, v111
    v_add_u32 v6, s13, v6
    v_add3_u32 v14, v14, v17, s10
    s_movk_i32 s11, -2172
    v_xor_b32 v7, 64, v6
    v_xor_b32 v8, 128, v6
    v_xor_b32 v9, 192, v6
    v_mad_i32_i24 v15, v15, s11, v14
    s_mul_i32 s10, s62, 10240
    s_cmp_ge_u32 s3, 8
    s_waitcnt lgkmcnt(0)
    s_barrier
    s_cbranch_scc1 K2_EPI_C
    ds_read_b128 v[30:33], v6 offset:0
    ds_read_b128 v[34:37], v7 offset:0
    ds_read_b128 v[38:41], v8 offset:0
    ds_read_b128 v[42:45], v9 offset:0
    ds_read_b128 v[46:49], v6 offset:8192
    ds_read_b128 v[50:53], v7 offset:8192
    ds_read_b128 v[54:57], v8 offset:8192
    ds_read_b128 v[58:61], v9 offset:8192
    ds_read_b128 v[62:65], v6 offset:16384
    ds_read_b128 v[66:69], v7 offset:16384
    ds_read_b128 v[70:73], v8 offset:16384
    ds_read_b128 v[74:77], v9 offset:16384
    s_waitcnt vmcnt(0)
    s_waitcnt lgkmcnt(8)
    v_mfma_f32_16x16x32_bf16 v[78:81], v[2:5], v[30:33], v[78:81]
    v_mfma_f32_16x16x32_bf16 v[78:81], v[10:13], v[34:37], v[78:81]
    v_mfma_f32_16x16x32_bf16 v[78:81], v[18:21], v[38:41], v[78:81]
    v_mfma_f32_16x16x32_bf16 v[78:81], v[26:29], v[42:45], v[78:81]
    s_waitcnt lgkmcnt(4)
    v_mfma_f32_16x16x32_bf16 v[82:85], v[2:5], v[46:49], v[82:85]
    v_mfma_f32_16x16x32_bf16 v[82:85], v[10:13], v[50:53], v[82:85]
    v_mfma_f32_16x16x32_bf16 v[82:85], v[18:21], v[54:57], v[82:85]
    v_mfma_f32_16x16x32_bf16 v[82:85], v[26:29], v[58:61], v[82:85]
    s_waitcnt lgkmcnt(0)
    v_mfma_f32_16x16x32_bf16 v[86:89], v[2:5], v[62:65], v[86:89]
    v_mfma_f32_16x16x32_bf16 v[86:89], v[10:13], v[66:69], v[86:89]
    v_mul_f32 v90, s56, v78
    v_mul_f32 v91, s56, v79
    v_mul_f32 v92, s56, v80
    v_mul_f32 v93, s56, v81
    v_mfma_f32_16x16x32_bf16 v[86:89], v[18:21], v[70:73], v[86:89]
    v_exp_f32 v90, v90
    v_exp_f32 v91, v91
    v_mfma_f32_16x16x32_bf16 v[86:89], v[26:29], v[74:77], v[86:89]
    v_exp_f32 v92, v92
    v_exp_f32 v93, v93
    v_pk_mul_f32 v[94:95], v[82:83], s[56:57]
    v_pk_mul_f32 v[96:97], v[84:85], s[56:57]
    v_exp_f32 v94, v94
    v_exp_f32 v95, v95
    v_exp_f32 v96, v96
    v_exp_f32 v97, v97
    v_pk_add_f32 v[90:91], v[90:91], s[44:45]
    v_pk_add_f32 v[92:93], v[92:93], s[44:45]
    v_rcp_f32 v90, v90
    v_rcp_f32 v91, v91
    v_rcp_f32 v92, v92
    v_rcp_f32 v93, v93
    v_pk_add_f32 v[94:95], v[94:95], s[44:45]
    v_pk_add_f32 v[96:97], v[96:97], s[44:45]
    v_mov_b32_dpp v86, v88 row_shr:8 row_mask:0xf bank_mask:0xc
    v_mov_b32_dpp v87, v89 row_shr:8 row_mask:0xf bank_mask:0xc
    v_rcp_f32 v94, v94
    v_rcp_f32 v95, v95
    v_rcp_f32 v96, v96
    v_rcp_f32 v97, v97
    v_pk_mul_f32 v[98:99], v[86:87], s[56:57]
    v_pk_mul_f32 v[90:91], v[90:91], v[78:79]
    v_pk_mul_f32 v[92:93], v[92:93], v[80:81]
    v_exp_f32 v98, v98
    v_exp_f32 v99, v99
    v_cvt_pk_bf16_f32 v90, v90, v91
    v_cvt_pk_bf16_f32 v91, v92, v93
    ds_write_b64 v14, v[90:91]
    v_pk_add_f32 v[98:99], v[98:99], s[44:45]
    v_pk_mul_f32 v[94:95], v[94:95], v[82:83]
    v_pk_mul_f32 v[96:97], v[96:97], v[84:85]
    v_rcp_f32 v98, v98
    v_rcp_f32 v99, v99
    v_cvt_pk_bf16_f32 v94, v94, v95
    v_cvt_pk_bf16_f32 v95, v96, v97
    ds_write_b64 v14, v[94:95] offset:4352
    v_pk_mul_f32 v[98:99], v[98:99], v[86:87]
    v_cvt_pk_bf16_f32 v98, v98, v99
    ds_write_b32 v15, v98 offset:8704
K2_EPI_C:
    s_waitcnt lgkmcnt(0)
    s_barrier
    ds_read_b128 v[36:39], v16
    s_waitcnt lgkmcnt(0)
    buffer_store_dwordx4 v[36:39], v110, s[36:39], s10 offen nt
K_END:
    s_endpgm
K2_MORESL:
    ds_read_b32 v35, v112 offset:524
    v_mov_b32 v114, 0x40000
    v_add_u32 v34, 1024, v42
    s_waitcnt lgkmcnt(0)
    v_subrev_u32 v35, 2, v35
    v_cmp_lt_i32 s[68:69], 0, v35
    v_cmp_lt_i32 s[70:71], 1, v35
    v_subrev_u32 v35, 2, v35
    v_cmp_lt_i32 vcc, 0, v35
    v_cndmask_b32 v42, v114, v34, s[68:69]
    v_cndmask_b32 v43, v114, v34, s[70:71]
K2_REDE:
    ds_read_b128 v[58:61], v42 offset:0
    ds_read_b128 v[62:65], v42 offset:256
    ds_read_b128 v[66:69], v43 offset:512
    ds_read_b128 v[70:73], v43 offset:768
    s_waitcnt lgkmcnt(0)
    v_pk_add_f32 v[102:103], v[102:103], v[58:59]
    v_pk_add_f32 v[104:105], v[104:105], v[60:61]
    v_pk_add_f32 v[106:107], v[106:107], v[62:63]
    v_pk_add_f32 v[108:109], v[108:109], v[64:65]
    v_pk_add_f32 v[102:103], v[102:103], v[66:67]
    v_pk_add_f32 v[104:105], v[104:105], v[68:69]
    v_pk_add_f32 v[106:107], v[106:107], v[70:71]
    v_pk_add_f32 v[108:109], v[108:109], v[72:73]
    s_cbranch_vccz K2_REDXE
    v_add_u32 v34, 1024, v34
    v_cmp_lt_i32 s[68:69], 0, v35
    v_cmp_lt_i32 s[70:71], 1, v35
    v_subrev_u32 v35, 2, v35
    v_cmp_lt_i32 vcc, 0, v35
    v_cndmask_b32 v42, v114, v34, s[68:69]
    v_cndmask_b32 v43, v114, v34, s[70:71]
    s_branch K2_REDE
K2_REDXE:
    s_branch K2_EPI_B
K2_OSLOW:
    s_waitcnt vmcnt(0) lgkmcnt(0)
    v_lshrrev_b32 v110, 1, v119
    v_mov_b32 v116, 0
    v_lshrrev_b32 v112, 5, v119
    s_mul_i32 s12, s3, 3072
    s_add_u32 s12, s12, 0x828000
    v_add_u32 v110, v110, v111
    s_add_u32 s12, s12, s19
    s_cmp_ge_u32 s3, 8
    ds_read_b32 v114, v116 offset:224
    ds_read_b128 v[70:73], v112 offset:512
    s_cbranch_scc1 K2_NW217
    buffer_load_dwordx4 v[2:5], v110, s[28:31], s12 offen offset:0 sc1
    buffer_load_dwordx4 v[10:13], v110, s[28:31], s12 offen offset:1024 sc1
    buffer_load_dwordx4 v[18:21], v110, s[28:31], s12 offen offset:2048 sc1
    buffer_load_dwordx4 v[26:29], v110, s[28:31], s12 offen offset:3072 sc1
K2_NW217:
    s_branch K2_OWT2
K2_OWAIT:
    v_pk_mul_f32 v[102:103], v[102:103], v[90:91]
    v_pk_mul_f32 v[104:105], v[104:105], v[92:93]
    v_pk_mul_f32 v[106:107], v[106:107], v[94:95]
    v_pk_mul_f32 v[108:109], v[108:109], v[96:97]
K2_OWT2:
    s_cmp_lg_u32 s41, 0
    s_cbranch_scc1 K2_ROUND
    v_pk_add_f32 v[90:91], s[44:45], 0
    v_pk_add_f32 v[92:93], s[44:45], 0
    v_pk_add_f32 v[94:95], s[44:45], 0
    v_pk_add_f32 v[96:97], s[44:45], 0
    s_mov_b32 s11, 65536
K2_OWL:
    ds_read_b32 v114, v116 offset:224
    ds_read_b128 v[70:73], v112 offset:512
    s_sub_u32 s11, s11, 1
    s_cbranch_scc1 K_END
    s_waitcnt lgkmcnt(0)
    v_readfirstlane_b32 s10, v114
    s_cmp_lg_u32 s10, 6
    s_cbranch_scc1 K2_OWL
    s_mov_b32 s13, 96768
    v_add3_u32 v116, v119, v111, s13
    v_add_u32 v42, v70, v111
    v_add_u32 v43, v71, v111
    v_add_u32 v118, v72, v116
    v_cmp_lt_i32 vcc, 2, v73
    ds_read_b128 v[58:61], v42 offset:0
    ds_read_b128 v[62:65], v42 offset:256
    ds_read_b128 v[66:69], v43 offset:512
    ds_read_b128 v[70:73], v43 offset:768
    ds_read_b128 v[50:53], v118
    ds_read_b128 v[54:57], v118 offset:256
    s_branch K2_OFAST
K2_ROUND:
    s_waitcnt vmcnt(0) lgkmcnt(0)
    s_barrier
    s_mov_b32 s79, 0
    v_mbcnt_lo_u32_b32 v98, -1, 0
    v_mbcnt_hi_u32_b32 v98, -1, v98
    s_lshl_b32 s10, s3, 6
    v_add_u32 v98, s10, v98
    s_cmp_ge_u32 s3, 10
    s_cbranch_scc1 K2_RND_B
    v_lshrrev_b32 v84, 5, v119
    ds_read2_b32 v[82:83], v84 offset0:128 offset1:131
    s_mov_b32 s10, 96768
    v_add3_u32 v120, v119, v111, s10
    v_mov_b32 v85, 0x40000
    s_waitcnt lgkmcnt(0)
    v_add_u32 v82, v82, v111
    v_cmp_lt_i32 s[68:69], 0, v83
    v_cmp_lt_i32 s[70:71], 1, v83
    v_subrev_u32 v83, 2, v83
    v_cmp_lt_i32 vcc, 0, v83
    v_cndmask_b32 v86, v85, v82, s[68:69]
    v_cndmask_b32 v87, v85, v82, s[70:71]
K2_REDR:
    ds_read_b128 v[66:69], v86 offset:0
    ds_read_b128 v[70:73], v86 offset:256
    ds_read_b128 v[74:77], v87 offset:512
    ds_read_b128 v[78:81], v87 offset:768
    s_waitcnt lgkmcnt(0)
    v_pk_add_f32 v[102:103], v[102:103], v[66:67]
    v_pk_add_f32 v[104:105], v[104:105], v[68:69]
    v_pk_add_f32 v[106:107], v[106:107], v[70:71]
    v_pk_add_f32 v[108:109], v[108:109], v[72:73]
    v_pk_add_f32 v[102:103], v[102:103], v[74:75]
    v_pk_add_f32 v[104:105], v[104:105], v[76:77]
    v_pk_add_f32 v[106:107], v[106:107], v[78:79]
    v_pk_add_f32 v[108:109], v[108:109], v[80:81]
    s_cbranch_vccz K2_REDXR
    v_add_u32 v82, 1024, v82
    v_cmp_lt_i32 s[68:69], 0, v83
    v_cmp_lt_i32 s[70:71], 1, v83
    v_subrev_u32 v83, 2, v83
    v_cmp_lt_i32 vcc, 0, v83
    v_cndmask_b32 v86, v85, v82, s[68:69]
    v_cndmask_b32 v87, v85, v82, s[70:71]
    s_branch K2_REDR
K2_REDXR:
    ds_write_b128 v120, v[102:105]
    ds_write_b128 v120, v[106:109] offset:256
K2_RND_B:
    v_and_b32 v127, 63, v98
    v_lshrrev_b32 v122, 4, v127
    v_and_b32 v123, 15, v127
    s_cmp_lt_u32 s3, 12
    s_cbranch_scc1 K2_RND_F
    s_mul_i32 s10, s3, 10240
    s_sub_u32 s10, s10, 67072
    v_mov_b32 v66, 0
    v_mov_b32 v67, 0
    v_mov_b32 v68, -1
    v_lshl_add_u32 v69, v127, 4, s10
    ds_write_b128 v69, v[66:69] offset:0
    ds_write_b128 v69, v[66:69] offset:1024
    ds_write_b128 v69, v[66:69] offset:2048
    ds_write_b128 v69, v[66:69] offset:3072
    ds_write_b128 v69, v[66:69] offset:4096
    ds_write_b128 v69, v[66:69] offset:5120
    ds_write_b128 v69, v[66:69] offset:6144
    ds_write_b128 v69, v[66:69] offset:7168
    ds_write_b128 v69, v[66:69] offset:8192
    ds_write_b128 v69, v[66:69] offset:9216
K2_RND_F:
    v_lshlrev_b32 v84, 2, v127
    v_mov_b32 v101, 0
    ds_write_b32 v84, v101 offset:256
    ds_write_b32 v101, v101 offset:200
    ds_write_b32 v101, v101 offset:224
    v_lshrrev_b32 v86, 2, v98
    v_and_b32 v121, 3, v98
    v_mul_u32_u24 v120, 20736, v86
    v_lshlrev_b32 v119, 2, v86
    v_cmp_lt_u32 vcc, 249, v86
    v_lshl_add_u32 v120, v121, 4, v120
    v_mov_b32 v86, 0x10000
    v_add_u32 v119, 162304, v119
    v_cndmask_b32 v121, v121, v86, vcc
    ds_read_b32 v100, v119
    s_or_b64 s[4:5], s[48:49], s[50:51]
    s_or_b64 s[6:7], s[52:53], s[54:55]
    s_or_b64 s[6:7], s[6:7], s[14:15]
    s_or_b64 s[4:5], s[4:5], s[6:7]
    s_cselect_b32 s6, 0, 1
    s_add_u32 s40, s40, s6
    s_mul_i32 s63, s40, 320
    s_add_u32 s63, s63, 0x280000
    s_add_u32 s63, s63, s19
    s_mul_i32 s7, s40, 20
    s_waitcnt lgkmcnt(0)
    v_sub_u32_sdwa v121, v100, v121 dst_sel:DWORD dst_unused:UNUSED_PAD src0_sel:WORD_1 src1_sel:DWORD
    v_add_u32_sdwa v120, v120, v100 dst_sel:DWORD dst_unused:UNUSED_PAD src0_sel:DWORD src1_sel:WORD_0
    v_subrev_u32 v121, s7, v121
    s_cmp_eq_u32 s6, 0
    s_cbranch_scc1 K2_RND_C
    v_cmp_lt_i32 s[48:49], 0, v121
    v_cmp_lt_i32 s[50:51], 4, v121
    v_cmp_lt_i32 s[52:53], 8, v121
    v_cmp_lt_i32 s[54:55], 12, v121
    v_cmp_lt_i32 s[14:15], 16, v121
K2_RND_C:
    s_mov_b64 s[68:69], s[48:49]
    v_mov_b32 v126, v98
    s_mov_b64 exec, s[68:69]
    buffer_load_dwordx4 v[84:87], v120, s[28:31], s63 offen offset:0 sc1
    s_mov_b64 exec, s[50:51]
    buffer_load_dwordx4 v[88:91], v120, s[28:31], s63 offen offset:64 sc1
    s_mov_b64 exec, s[52:53]
    buffer_load_dwordx4 v[92:95], v120, s[28:31], s63 offen offset:128 sc1
    s_mov_b64 exec, s[54:55]
    buffer_load_dwordx4 v[96:99], v120, s[28:31], s63 offen offset:192 sc1
    s_mov_b64 exec, s[14:15]
    buffer_load_dwordx4 v[100:103], v120, s[28:31], s63 offen offset:256 sc1
K2_RL18:
    s_mov_b64 exec, -1
    v_mov_b32 v58, 16
    v_lshlrev_b32 v69, 2, v127
    v_and_b32 v104, 7, v127
    v_subrev_u32 v82, 640, v126
    v_cmp_eq_u32 vcc, 0, v104
    v_lshrrev_b32 v82, 3, v82
    v_lshlrev_b32 v81, 9, v82
    v_lshlrev_b32 v80, 6, v104
    v_or_b32 v83, 0x40000, v81
    v_lshl_add_u32 v80, v82, 10, v80
    v_lshlrev_b32 v82, 2, v82
    v_add_u32 v80, 56192, v80
    v_cndmask_b32 v81, v81, v83, vcc
    v_lshlrev_b32 v83, 3, v104
    v_and_b32 v73, 3, v127
    v_cmp_eq_u32 vcc, v73, v122
    v_lshlrev_b32 v70, 3, v122
    v_lshlrev_b32 v71, 1, v127
    v_mov_b32 v73, 0x40000
    v_and_b32 v71, 24, v71
    v_cndmask_b32 v73, v73, 0, vcc
    v_mov_b32 v106, 0
    s_waitcnt vmcnt(0) lgkmcnt(0)
    s_barrier
    s_branch K2_LATER
K2_REDO:
    s_mov_b32 s43, s18
    s_waitcnt vmcnt(0) lgkmcnt(0)
    v_mbcnt_lo_u32_b32 v58, -1, 0
    v_mbcnt_hi_u32_b32 v58, -1, v58
    v_lshrrev_b32 v59, 4, v58
    v_and_b32 v73, 3, v58
    v_cmp_eq_u32 vcc, v73, v59
    v_lshlrev_b32 v70, 3, v59
    v_lshlrev_b32 v71, 1, v58
    v_mov_b32 v73, 0x40000
    v_and_b32 v71, 24, v71
    v_cndmask_b32 v73, v73, 0, vcc
    v_mul_u32_u24 v122, s77, v70
    v_mad_u32_u24 v123, v71, s77, v73
    v_add_u32 v122, s76, v122
    v_add_u32 v123, s76, v123
    s_cmp_lt_u32 s3, 10
    s_cselect_b64 exec, -1, 0
    v_mov_b32 v125, 96768
    s_mov_b64 exec, -1
    ds_read2_b64 v[58:61], v122 offset0:0 offset1:1
    ds_read2_b32 v[62:63], v123 offset0:0 offset1:2
    ds_read_b32 v118, v122 offset:16
    s_waitcnt lgkmcnt(2)
    ds_read_u16 v110, v58 offset:8
    ds_read_u16 v112, v58 offset:24
    ds_read_u16 v114, v58 offset:40
    ds_read_u16 v116, v58 offset:56
    v_and_or_b32 v121, v59, s60, v111
    v_mov_b32 v119, v61
    v_add_u32 v120, v125, v121
    s_waitcnt lgkmcnt(0)
    buffer_load_dwordx4 v[2:5], v[110:111], s[32:35], s19 idxen offen sc1
    buffer_load_dwordx4 v[10:13], v[112:113], s[32:35], s19 idxen offen sc1
    buffer_load_dwordx4 v[18:21], v[114:115], s[32:35], s19 idxen offen sc1
    buffer_load_dwordx4 v[26:29], v[116:117], s[32:35], s19 idxen offen sc1
    ds_read_b64 v[34:35], v62 offset:0
    ds_read_b64 v[38:39], v62 offset:16
    ds_read_b64 v[42:43], v62 offset:32
    ds_read_b64 v[46:47], v62 offset:48
    ds_read_b128 v[50:53], v121 offset:34816
    ds_read_b128 v[54:57], v121 offset:35072
    v_mov_b32 v124, v63
    ds_read_u16 v110, v60 offset:8
    ds_read_u16 v112, v60 offset:24
    ds_read_u16 v114, v60 offset:40
    ds_read_u16 v116, v60 offset:56
    v_pk_mul_f32 v[102:103], s[44:45], 0
    v_pk_mul_f32 v[104:105], s[44:45], 0
    v_pk_mul_f32 v[106:107], s[44:45], 0
    v_pk_mul_f32 v[108:109], s[44:45], 0
    s_cmp_ge_u32 s3, 10
    s_cbranch_scc1 K2_REDO2
    v_lshrrev_b32 v78, 7, v59
    v_add_u32 v76, s79, v120
    ds_read_b32 v78, v78 offset:256
    ds_read_b128 v[102:105], v76
    ds_read_b128 v[106:109], v76 offset:256
    s_waitcnt lgkmcnt(0)
    v_exp_f32 v58, v50
    v_exp_f32 v59, v51
    v_exp_f32 v60, v52
    v_exp_f32 v61, v53
    v_exp_f32 v62, v54
    v_exp_f32 v63, v55
    v_exp_f32 v64, v56
    v_exp_f32 v65, v57
    v_min_u32 v78, 0x400, v78
    v_add_u32 v75, s24, v78
    v_and_b32 v75, s25, v75
    v_max_u32 v75, 384, v75
    v_sub_u32 v78, v75, v78
    v_pk_add_f32 v[58:59], v[58:59], s[44:45]
    v_pk_add_f32 v[60:61], v[60:61], s[44:45]
    v_pk_add_f32 v[62:63], v[62:63], s[44:45]
    v_pk_add_f32 v[64:65], v[64:65], s[44:45]
    v_cvt_f32_u32 v78, v78
    v_rcp_f32 v58, v58
    v_rcp_f32 v59, v59
    v_rcp_f32 v60, v60
    v_rcp_f32 v61, v61
    v_rcp_f32 v62, v62
    v_rcp_f32 v63, v63
    v_rcp_f32 v64, v64
    v_rcp_f32 v65, v65
    v_mul_f32 v78, 0xbd800000, v78
    v_pk_mul_f32 v[58:59], v[50:51], v[58:59]
    v_pk_mul_f32 v[60:61], v[52:53], v[60:61]
    v_pk_mul_f32 v[62:63], v[54:55], v[62:63]
    v_pk_mul_f32 v[64:65], v[56:57], v[64:65]
    v_pk_fma_f32 v[102:103], v[58:59], v[78:79], v[102:103] op_sel_hi:[1,0,1]
    v_pk_fma_f32 v[104:105], v[60:61], v[78:79], v[104:105] op_sel_hi:[1,0,1]
    v_pk_fma_f32 v[106:107], v[62:63], v[78:79], v[106:107] op_sel_hi:[1,0,1]
    v_pk_fma_f32 v[108:109], v[64:65], v[78:79], v[108:109] op_sel_hi:[1,0,1]
K2_REDO2:
    s_mov_b32 s72, 8
    s_mov_b32 s73, 8
    s_waitcnt vmcnt(0) lgkmcnt(0)
    v_mfma_f32_16x16x32_bf16 v[58:61], v[34:37], v[0:3], v[50:53]
    v_mfma_f32_16x16x32_bf16 v[62:65], v[38:41], v[8:11], v[50:53]
    v_mfma_f32_16x16x32_bf16 v[66:69], v[42:45], v[16:19], v[50:53]
    v_mfma_f32_16x16x32_bf16 v[70:73], v[46:49], v[24:27], v[50:53]
    s_nop 7
K2_SLOOP:
    v_exp_f32 v90, v58
    v_mfma_f32_16x16x32_bf16 v[74:77], v[32:35], v[4:7], v[54:57]
    v_exp_f32 v91, v59
    v_exp_f32 v92, v60
    v_mfma_f32_16x16x32_bf16 v[78:81], v[36:39], v[12:15], v[54:57]
    v_exp_f32 v93, v61
    v_exp_f32 v94, v62
    v_mfma_f32_16x16x32_bf16 v[82:85], v[40:43], v[20:23], v[54:57]
    v_exp_f32 v95, v63
    v_exp_f32 v96, v64
    v_mfma_f32_16x16x32_bf16 v[86:89], v[44:47], v[28:31], v[54:57]
    v_exp_f32 v97, v65
    s_waitcnt lgkmcnt(0)
    v_cmp_lt_u32 vcc, s60, v119
    buffer_load_dwordx4 v[2:5], v[110:111], s[32:35], s19 idxen offen sc1
    buffer_load_dwordx4 v[10:13], v[112:113], s[32:35], s19 idxen offen sc1
    buffer_load_dwordx4 v[18:21], v[114:115], s[32:35], s19 idxen offen sc1
    buffer_load_dwordx4 v[26:29], v[116:117], s[32:35], s19 idxen offen sc1
    ds_read_b64 v[34:35], v124 offset:0
    ds_read_b64 v[38:39], v124 offset:16
    ds_read_b64 v[42:43], v124 offset:32
    ds_read_b64 v[46:47], v124 offset:48
    s_cbranch_vccz K2_NQ20
    s_mov_b64 exec, vcc
    v_and_or_b32 v121, v119, s60, v111
    ds_read_b128 v[50:53], v121 offset:34816
    ds_read_b128 v[54:57], v121 offset:35072
    s_mov_b64 exec, -1
K2_NQ20:
    ds_read_u16 v110, v118 offset:8
    ds_read_u16 v112, v118 offset:24
    ds_read_u16 v114, v118 offset:40
    ds_read_u16 v116, v118 offset:56
    ds_read_b32 v124, v123 offset:16
K2_NL19:
    v_exp_f32 v98, v66
    v_exp_f32 v99, v67
    v_exp_f32 v100, v68
    v_exp_f32 v101, v69
    v_add_f32 v90, 1.0, v90
    v_add_f32 v91, 1.0, v91
    v_add_f32 v92, 1.0, v92
    v_add_f32 v93, 1.0, v93
    v_add_f32 v94, 1.0, v94
    v_add_f32 v95, 1.0, v95
    v_add_f32 v96, 1.0, v96
    v_add_f32 v97, 1.0, v97
    v_add_f32 v98, 1.0, v98
    v_add_f32 v99, 1.0, v99
    v_add_f32 v100, 1.0, v100
    v_add_f32 v101, 1.0, v101
    v_rcp_f32 v90, v90
    v_rcp_f32 v91, v91
    v_rcp_f32 v92, v92
    v_rcp_f32 v93, v93
    v_rcp_f32 v94, v94
    v_rcp_f32 v95, v95
    v_rcp_f32 v96, v96
    v_rcp_f32 v97, v97
    v_rcp_f32 v98, v98
    v_rcp_f32 v99, v99
    v_rcp_f32 v100, v100
    v_rcp_f32 v101, v101
    s_nop 0
    v_fmac_f32 v102, v58, v90
    v_fmac_f32 v103, v59, v91
    v_fmac_f32 v104, v60, v92
    v_fmac_f32 v105, v61, v93
    v_fmac_f32 v102, v62, v94
    v_fmac_f32 v103, v63, v95
    v_fmac_f32 v104, v64, v96
    v_fmac_f32 v105, v65, v97
    v_fmac_f32 v102, v66, v98
    v_fmac_f32 v103, v67, v99
    v_fmac_f32 v104, v68, v100
    v_fmac_f32 v105, v69, v101
    v_exp_f32 v94, v70
    v_exp_f32 v95, v71
    v_exp_f32 v96, v72
    v_exp_f32 v97, v73
    s_nop 0
    v_add_f32 v94, 1.0, v94
    v_add_f32 v95, 1.0, v95
    v_add_f32 v96, 1.0, v96
    v_add_f32 v97, 1.0, v97
    v_rcp_f32 v94, v94
    v_rcp_f32 v95, v95
    v_rcp_f32 v96, v96
    v_rcp_f32 v97, v97
    s_nop 0
    v_fmac_f32 v102, v70, v94
    v_fmac_f32 v103, v71, v95
    v_fmac_f32 v104, v72, v96
    v_fmac_f32 v105, v73, v97
    v_exp_f32 v90, v74
    s_waitcnt vmcnt(3) lgkmcnt(0)
    v_mfma_f32_16x16x32_bf16 v[58:61], v[34:37], v[0:3], v[50:53]
    v_exp_f32 v91, v75
    v_exp_f32 v92, v76
    s_waitcnt vmcnt(2)
    v_mfma_f32_16x16x32_bf16 v[62:65], v[38:41], v[8:11], v[50:53]
    v_exp_f32 v93, v77
    v_exp_f32 v94, v78
    s_waitcnt vmcnt(1)
    v_mfma_f32_16x16x32_bf16 v[66:69], v[42:45], v[16:19], v[50:53]
    v_exp_f32 v95, v79
    v_exp_f32 v96, v80
    s_waitcnt vmcnt(0)
    v_mfma_f32_16x16x32_bf16 v[70:73], v[46:49], v[24:27], v[50:53]
    v_exp_f32 v97, v81
    v_exp_f32 v98, v82
    v_exp_f32 v99, v83
    v_exp_f32 v100, v84
    v_exp_f32 v101, v85
    v_add_f32 v90, 1.0, v90
    v_add_f32 v91, 1.0, v91
    v_add_f32 v92, 1.0, v92
    v_add_f32 v93, 1.0, v93
    v_add_f32 v94, 1.0, v94
    v_add_f32 v95, 1.0, v95
    v_add_f32 v96, 1.0, v96
    v_add_f32 v97, 1.0, v97
    v_add_f32 v98, 1.0, v98
    v_add_f32 v99, 1.0, v99
    v_add_f32 v100, 1.0, v100
    v_add_f32 v101, 1.0, v101
    v_rcp_f32 v90, v90
    v_rcp_f32 v91, v91
    v_rcp_f32 v92, v92
    v_rcp_f32 v93, v93
    v_rcp_f32 v94, v94
    v_rcp_f32 v95, v95
    v_rcp_f32 v96, v96
    v_rcp_f32 v97, v97
    v_rcp_f32 v98, v98
    v_rcp_f32 v99, v99
    v_rcp_f32 v100, v100
    v_rcp_f32 v101, v101
    s_nop 0
    v_fmac_f32 v106, v74, v90
    v_fmac_f32 v107, v75, v91
    v_fmac_f32 v108, v76, v92
    v_fmac_f32 v109, v77, v93
    v_fmac_f32 v106, v78, v94
    v_fmac_f32 v107, v79, v95
    v_fmac_f32 v108, v80, v96
    v_fmac_f32 v109, v81, v97
    v_fmac_f32 v106, v82, v98
    v_fmac_f32 v107, v83, v99
    v_fmac_f32 v108, v84, v100
    v_fmac_f32 v109, v85, v101
    v_exp_f32 v94, v86
    v_exp_f32 v95, v87
    v_exp_f32 v96, v88
    v_exp_f32 v97, v89
    s_nop 0
    v_add_f32 v94, 1.0, v94
    v_add_f32 v95, 1.0, v95
    v_add_f32 v96, 1.0, v96
    v_add_f32 v97, 1.0, v97
    v_rcp_f32 v94, v94
    v_rcp_f32 v95, v95
    v_rcp_f32 v96, v96
    v_rcp_f32 v97, v97
    s_nop 0
    v_fmac_f32 v106, v86, v94
    v_fmac_f32 v107, v87, v95
    v_fmac_f32 v108, v88, v96
    v_fmac_f32 v109, v89, v97
    s_cbranch_vccz K2_NF21
    s_mov_b64 exec, vcc
    ds_write_b128 v120, v[102:105]
    ds_write_b128 v120, v[106:109] offset:256
    ds_read_b128 v[102:105], v119
    ds_read_b128 v[106:109], v119
    v_add_u32 v120, v125, v121
    s_mov_b64 exec, -1
K2_NF21:
    ds_read2_b32 v[118:119], v122 offset0:6 offset1:5
    v_lshl_add_u64 v[122:123], v[122:123], 0, s[72:73]
    s_sub_u32 s43, s43, 1
    s_cmp_lg_u32 s43, 0
    s_cbranch_scc1 K2_SLOOP
    s_branch K2_FLUSH
K2_WFL:
    s_mov_b32 s11, 65536
    v_lshrrev_b32 v127, 4, v83
K2_FLG:
    s_sleep 4
    v_and_b32 v79, 3, v127
    s_add_u32 s10, s19, 0x810000
    v_lshlrev_b32 v79, 6, v79
    buffer_load_dword v79, v79, s[28:31], s10 offen sc1
    s_sub_u32 s11, s11, 1
    s_cbranch_scc1 K_END
    s_waitcnt vmcnt(0)
    v_cmp_ne_u32 vcc, s47, v79
    s_cbranch_vccnz K2_FLG
    s_lshl_b32 s10, s3, 12
    s_add_u32 s10, s10, 0x820000
    s_add_u32 s10, s10, s19
    buffer_load_dwordx4 v[84:87], v83, s[28:31], s10 offen offset:0 sc1
    buffer_load_dwordx4 v[88:91], v83, s[28:31], s10 offen offset:1024 sc1
    buffer_load_dwordx4 v[92:95], v83, s[28:31], s10 offen offset:2048 sc1
    buffer_load_dwordx4 v[96:99], v83, s[28:31], s10 offen offset:3072 sc1
    s_waitcnt vmcnt(0)
    s_branch K2_WFD
K2_SKIP:
    v_cmp_ne_u32 vcc, 0, v78
    s_cbranch_vccnz K2_CORR
    s_branch K2_OSLOW
K2_REM:
    ds_read_b32 v101, v69 offset:256
    s_sub_u32 s9, s3, 10
    s_and_b32 s8, s9, 1
    s_lshr_b32 s6, s9, 2
    s_lshl1_add_u32 s6, s6, s8
    s_waitcnt lgkmcnt(0)
    v_min_u32 v100, 0x400, v101
    v_readlane_b32 s41, v101, 63
    v_add_u32 v101, -336, v100
    v_ashrrev_i32 v101, 6, v101
    v_and_b32 v92, 48, v100
    v_max_i32 v101, 0, v101
    v_subrev_u32 v92, 16, v92
    v_cmp_lt_u32 vcc, 0, v101
    v_cmp_gt_u32 s[16:17], 32, v92
    s_cmp_eq_u32 s41, 0
    s_cselect_b32 s10, s79, 0
    s_and_b64 s[16:17], s[16:17], vcc
    s_cmp_lg_u32 s10, 0
    s_cselect_b64 s[16:17], s[16:17], 0
    s_bcnt1_i32_b64 s58, s[16:17]
    v_subb_co_u32 v101, vcc, v101, 0, s[16:17]
    v_lshlrev_b32 v92, 16, v101
    s_nop 0
    v_add_u32_dpp v102, v101, v101 row_shr:1 row_mask:0xf bank_mask:0xf bound_ctrl:0
    s_nop 1
    v_add_u32_dpp v102, v102, v102 row_shr:2 row_mask:0xf bank_mask:0xf
    s_nop 1
    v_add_u32_dpp v102, v102, v102 row_shr:4 row_mask:0xf bank_mask:0xf
    s_nop 1
    v_add_u32_dpp v102, v102, v102 row_shr:8 row_mask:0xf bank_mask:0xf
    s_nop 1
    v_add_u32_dpp v102, v102, v102 row_bcast:15 row_mask:0xa bank_mask:0xf
    s_nop 1
    v_add_u32_dpp v102, v102, v102 row_bcast:31 row_mask:0xc bank_mask:0xf
    v_sub_u32 v103, v102, v101
    v_readlane_b32 s7, v102, 63
    v_lshl_add_u32 v92, v103, 3, v92
    ds_bpermute_b32 v93, v82, v92
    s_add_u32 s4, s7, 3
    s_lshr_b32 s4, s4, 2
    s_add_u32 s58, s58, 3
    s_lshr_b32 s58, s58, 2
    s_lshl1_add_u32 s5, s4, s58
    s_sub_i32 s5, s5, 19
    s_ashr_i32 s5, s5, 2
    s_max_i32 s5, s5, 0
    s_and_b32 s25, s5, 1
    s_lshr_b32 s5, s5, 1
    s_cmp_lt_u32 s58, 2
    s_cselect_b32 s25, 0, s25
    s_cmp_gt_u32 s58, 8
    s_cselect_b32 s25, 1, s25
    s_lshl_b32 s11, s5, 1
    s_sub_u32 s4, s4, s11
    s_lshr_b32 s12, s4, 2
    s_and_b32 s13, s4, 3
    s_cmp_lt_u32 s6, s13
    s_addc_u32 s43, s12, 0
    s_mul_i32 s10, s6, s12
    s_min_u32 s13, s6, s13
    s_add_u32 s10, s10, s13
    s_add_u32 s10, s10, s11
    s_lshl_b32 s26, s25, 1
    s_sub_u32 s58, s58, s26
    s_and_b32 s27, s4, 1
    s_lshl1_add_u32 s27, s27, s58
    s_add_u32 s27, s27, 1
    s_lshr_b32 s27, s27, 1
    s_min_u32 s27, s27, 4
    s_min_u32 s27, s27, s58
    s_sub_u32 s58, s58, s27
    s_cmp_lg_u32 s8, 0
    s_cselect_b32 s59, s58, 0
    s_cselect_b32 s58, s27, s58
    s_add_u32 s59, s59, s26
    s_lshr_b32 s27, s58, 1
    s_sub_u32 s58, s58, s27
    s_cmp_lt_u32 s9, 4
    s_cselect_b32 s58, s27, s58
    s_cselect_b32 s27, 0, s27
    s_add_u32 s59, s59, s27
    s_mul_i32 s27, s8, s25
    s_mul_i32 s8, s8, s5
    s_bitcmp1_b32 s9, 1
    s_cselect_b32 s58, s25, s58
    s_cselect_b32 s59, s27, s59
    s_cselect_b32 s43, s5, s43
    s_cselect_b32 s10, s8, s10
    s_lshl_b32 s10, s10, 5
    s_add_u32 s76, s10, 1152
    s_mov_b32 s77, s43
    s_cmp_eq_u32 s3, 15
    s_cbranch_scc1 K2_TAIL
    s_waitcnt lgkmcnt(0)
    v_cmp_lt_u32_sdwa vcc, v104, v93 src0_sel:DWORD src1_sel:WORD_1
    v_add_u32_sdwa v94, v93, v83 dst_sel:DWORD dst_unused:UNUSED_PAD src0_sel:WORD_0 src1_sel:DWORD
    v_add_u32 v95, 8, v104
    s_mov_b64 exec, vcc
    ds_write_b64 v94, v[80:81] offset:1152
    v_cmp_lt_u32_sdwa vcc, v95, v93 src0_sel:DWORD src1_sel:WORD_1
    s_cbranch_vccz K2_SETUP
    s_mov_b64 exec, vcc
    v_add_u32 v96, 512, v80
    v_and_b32 v97, s60, v81
    ds_write_b64 v94, v[96:97] offset:1216
    s_branch K2_SETUP
K2_TAIL:
    v_add_u32 v84, s7, v127
    v_lshlrev_b32 v84, 3, v84
    v_mov_b32 v86, 0
    v_mov_b32 v87, 0x45000
    s_mov_b64 exec, 0xff
    ds_write_b64 v84, v[86:87] offset:1152
    s_cmp_eq_u64 s[16:17], 0
    s_cbranch_scc1 K2_SETUP
    s_mov_b64 exec, -1
    v_mbcnt_lo_u32_b32 v84, s16, 0
    v_subrev_u32 v85, 40, v127
    v_mbcnt_hi_u32_b32 v84, s17, v84
    v_max_i32 v85, 0, v85
    v_lshl_add_u32 v88, v127, 4, v101
    s_mov_b32 s10, 56192
    s_mov_b32 s11, 162304
    v_add_u32 v84, v84, v85
    v_lshl_add_u32 v88, v88, 6, s10
    v_lshlrev_b32 v89, 9, v127
    v_lshl_add_u32 v84, v84, 3, s11
    v_cndmask_b32 v88, v86, v88, s[16:17]
    v_cndmask_b32 v89, v87, v89, s[16:17]
    s_mov_b32 exec_lo, s16
    s_or_b32 exec_hi, s17, 0xff00
    ds_write_b64 v84, v[88:89]
K2_SETUP:
    s_mov_b64 exec, 1
    ds_add_u32 v106, v58 offset:200
    s_mov_b64 exec, -1
    v_mul_u32_u24 v122, s43, v70
    v_mad_u32_u24 v123, v71, s43, v73
    v_add_u32 v122, s76, v122
    v_add_u32 v123, s76, v123
    s_cmp_eq_u32 s58, 0
    s_cbranch_scc1 K2_NPJ
    s_lshl_b32 s10, s59, 5
    s_add_u32 s10, s10, 162304
    s_mov_b32 s24, 0
    v_add_u32 v98, s10, v70
    v_add3_u32 v99, v71, v73, s10
    s_mov_b32 s10, 65536
    s_branch K2_B6P
K2_B6WP:
    ds_read_b32 v64, v106 offset:200
    s_sub_u32 s10, s10, 1
    s_cbranch_scc1 K_END
    s_waitcnt lgkmcnt(0)
    v_readfirstlane_b32 s11, v64
    s_cmp_lt_u32 s11, 96
    s_cbranch_scc1 K2_B6WP
K2_B6P:
    ds_read_b32 v64, v106 offset:200
K2_PJ:
    ds_read2_b64 v[58:61], v98 offset0:0 offset1:4
    ds_read2_b32 v[62:63], v99 offset0:0 offset1:8
    s_cmp_lg_u32 s24, 0
    s_cbranch_scc1 K2_PJ2
    s_waitcnt lgkmcnt(2)
    v_readfirstlane_b32 s11, v64
    s_cmp_lt_u32 s11, 96
    s_cbranch_scc1 K2_B6WP
K2_PJ2:
    s_waitcnt lgkmcnt(1)
    ds_read_u16 v110, v58 offset:8
    ds_read_u16 v112, v58 offset:24
    ds_read_u16 v114, v60 offset:8
    ds_read_u16 v116, v60 offset:24
    v_or_b32 v108, v59, v111
    v_or_b32 v109, v61, v111
    s_waitcnt lgkmcnt(0)
    buffer_load_dwordx4 v[2:5], v[110:111], s[32:35], s19 idxen offen sc1
    buffer_load_dwordx4 v[10:13], v[112:113], s[32:35], s19 idxen offen sc1
    buffer_load_dwordx4 v[18:21], v[114:115], s[32:35], s19 idxen offen sc1
    buffer_load_dwordx4 v[26:29], v[116:117], s[32:35], s19 idxen offen sc1
    ds_read_b64 v[34:35], v62 offset:0
    ds_read_b64 v[38:39], v62 offset:16
    ds_read_b64 v[42:43], v63 offset:0
    ds_read_b64 v[46:47], v63 offset:16
    ds_read_b128 v[50:53], v108 offset:34816
    ds_read_b128 v[54:57], v108 offset:35072
    ds_read_b128 v[70:73], v109 offset:34816
    ds_read_b128 v[86:89], v109 offset:35072
    v_add_u32 v108, 96768, v108
    v_add_u32 v109, 96768, v109
    s_cmp_lg_u32 s24, 0
    s_cbranch_scc1 K2_NONS
    s_branch K2_NPJ2
K2_NPJ:
    s_mov_b32 s10, 65536
    s_branch K2_B6
K2_B6W:
    ds_read_b32 v64, v106 offset:200
    s_sub_u32 s10, s10, 1
    s_cbranch_scc1 K_END
    s_waitcnt lgkmcnt(0)
    v_readfirstlane_b32 s11, v64
    s_cmp_lt_u32 s11, 96
    s_cbranch_scc1 K2_B6W
K2_B6:
    ds_read_b32 v64, v106 offset:200
    ds_read2_b64 v[58:61], v122 offset0:0 offset1:1
    ds_read2_b32 v[62:63], v123 offset0:0 offset1:2
    ds_read_b32 v118, v122 offset:16
    s_waitcnt lgkmcnt(3)
    v_readfirstlane_b32 s11, v64
    s_cmp_lt_u32 s11, 96
    s_cbranch_scc1 K2_B6W
    s_waitcnt lgkmcnt(2)
    ds_read_u16 v110, v58 offset:8
    ds_read_u16 v112, v58 offset:24
    ds_read_u16 v114, v58 offset:40
    ds_read_u16 v116, v58 offset:56
    v_and_or_b32 v121, v59, s60, v111
    v_mov_b32 v119, v61
    v_add_u32 v120, v125, v121
    s_waitcnt lgkmcnt(0)
    buffer_load_dwordx4 v[2:5], v[110:111], s[32:35], s19 idxen offen sc1
    buffer_load_dwordx4 v[10:13], v[112:113], s[32:35], s19 idxen offen sc1
    buffer_load_dwordx4 v[18:21], v[114:115], s[32:35], s19 idxen offen sc1
    buffer_load_dwordx4 v[26:29], v[116:117], s[32:35], s19 idxen offen sc1
    ds_read_b64 v[34:35], v62 offset:0
    ds_read_b64 v[38:39], v62 offset:16
    ds_read_b64 v[42:43], v62 offset:32
    ds_read_b64 v[46:47], v62 offset:48
    ds_read_b128 v[50:53], v121 offset:34816
    ds_read_b128 v[54:57], v121 offset:35072
    v_mov_b32 v124, v63
    ds_read_u16 v110, v60 offset:8
    ds_read_u16 v112, v60 offset:24
    ds_read_u16 v114, v60 offset:40
    ds_read_u16 v116, v60 offset:56
K2_NPJ2:
    s_cmp_lg_u32 s3, 14
    s_cbranch_scc1 K2_NONS
    s_and_b32 s13, s4, 3
    s_add_u32 s8, s12, 1
    s_mul_i32 s9, s8, s13
    s_lshl_b32 s6, s5, 3
    s_lshl2_add_u32 s9, s9, s6
    s_lshl2_add_u32 s13, s13, 8
    v_cvt_f32_u32 v76, s5
    v_cvt_f32_u32 v77, s8
    v_cvt_f32_u32 v78, s12
    v_rcp_f32 v76, v76
    v_rcp_f32 v77, v77
    v_rcp_f32 v78, v78
    v_subrev_u32 v102, 1, v102
    v_mov_b32 v79, s6
    v_mov_b32 v80, s9
    v_mov_b32 v81, s13
    v_cmp_gt_u32 vcc, s9, v103
    v_cmp_gt_u32 s[10:11], s6, v103
    s_nop 0
    v_cndmask_b32 v82, v80, v79, vcc
    v_cndmask_b32 v83, v78, v77, vcc
    v_cndmask_b32 v84, v81, 8, vcc
    v_cndmask_b32 v82, v82, 0, s[10:11]
    v_cndmask_b32 v83, v83, v76, s[10:11]
    v_cndmask_b32 v84, v84, 0, s[10:11]
    v_sub_u32 v103, v103, v82
    v_cvt_f32_u32 v103, v103
    v_add_f32 v103, 0.5, v103
    v_mul_f32 v103, v103, v83
    v_cvt_u32_f32 v103, v103
    v_add_u32 v103, v103, v84
    v_cmp_gt_u32 vcc, s9, v102
    v_cmp_gt_u32 s[10:11], s6, v102
    s_nop 0
    v_cndmask_b32 v82, v80, v79, vcc
    v_cndmask_b32 v83, v78, v77, vcc
    v_cndmask_b32 v84, v81, 8, vcc
    v_cndmask_b32 v82, v82, 0, s[10:11]
    v_cndmask_b32 v83, v83, v76, s[10:11]
    v_cndmask_b32 v84, v84, 0, s[10:11]
    v_sub_u32 v102, v102, v82
    v_cvt_f32_u32 v102, v102
    v_add_f32 v102, 0.5, v102
    v_mul_f32 v102, v102, v83
    v_cvt_u32_f32 v102, v102
    v_add_u32 v102, v102, v84
    v_cmp_lt_u32 vcc, 0, v101
    v_sub_u32 v83, v102, v103
    v_add_u32 v80, v103, v127
    v_add_u32 v83, 1, v83
    s_mov_b32 s10, 117248
    v_mov_b32 v82, 0x40000
    v_cndmask_b32 v83, 0, v83, vcc
    v_lshl_add_u32 v80, v80, 9, s10
    v_cmp_lt_u32 s[10:11], 1, v83
    v_lshlrev_b32 v76, 4, v127
    v_cndmask_b32 v80, v82, v80, vcc
    v_cndmask_b32 v81, v82, v80, s[10:11]
    v_cndmask_b32 v82, v82, 0, s[16:17]
    s_mov_b32 exec_hi, 0xff
    ds_write_b128 v76, v[80:83] offset:512
    s_mov_b32 exec_hi, -1
K2_NONS:
    s_cmp_eq_u32 s58, 0
    s_cbranch_scc1 K2_PJX
    v_mov_b32 v126, 0
    v_mov_b32 v127, 0
    s_cmp_eq_u32 s58, 1
    s_waitcnt vmcnt(0) lgkmcnt(0)
    v_mfma_f32_16x16x32_bf16 v[58:61], v[34:37], v[0:3], v[50:53]
    v_mfma_f32_16x16x32_bf16 v[62:65], v[38:41], v[8:11], v[50:53]
    v_mfma_f32_16x16x32_bf16 v[74:77], v[32:35], v[4:7], v[54:57]
    v_mfma_f32_16x16x32_bf16 v[78:81], v[36:39], v[12:15], v[54:57]
    s_cbranch_scc1 K2_PJ3
    v_mfma_f32_16x16x32_bf16 v[66:69], v[42:45], v[16:19], v[70:73]
    v_mfma_f32_16x16x32_bf16 v[70:73], v[46:49], v[24:27], v[70:73]
    v_mfma_f32_16x16x32_bf16 v[82:85], v[40:43], v[20:23], v[86:89]
    v_mfma_f32_16x16x32_bf16 v[86:89], v[44:47], v[28:31], v[86:89]
K2_PJ3:
    ds_read2_b64 v[102:105], v122 offset0:0 offset1:1
    ds_read2_b32 v[106:107], v123 offset0:0 offset1:2
    ds_read_b32 v118, v122 offset:16
    s_waitcnt lgkmcnt(2)
    ds_read_u16 v110, v102 offset:8
    ds_read_u16 v112, v102 offset:24
    ds_read_u16 v114, v102 offset:40
    ds_read_u16 v116, v102 offset:56
    v_and_or_b32 v121, v103, s60, v111
    v_mov_b32 v119, v105
    v_add_u32 v120, v125, v121
    s_waitcnt lgkmcnt(0)
    buffer_load_dwordx4 v[2:5], v[110:111], s[32:35], s19 idxen offen sc1
    buffer_load_dwordx4 v[10:13], v[112:113], s[32:35], s19 idxen offen sc1
    buffer_load_dwordx4 v[18:21], v[114:115], s[32:35], s19 idxen offen sc1
    buffer_load_dwordx4 v[26:29], v[116:117], s[32:35], s19 idxen offen sc1
    ds_read_b64 v[34:35], v106 offset:0
    ds_read_b64 v[38:39], v106 offset:16
    ds_read_b64 v[42:43], v106 offset:32
    ds_read_b64 v[46:47], v106 offset:48
    ds_read_b128 v[50:53], v121 offset:34816
    ds_read_b128 v[54:57], v121 offset:35072
    v_mov_b32 v124, v107
    ds_read_u16 v110, v104 offset:8
    ds_read_u16 v112, v104 offset:24
    ds_read_u16 v114, v104 offset:40
    ds_read_u16 v116, v104 offset:56
    s_cmp_lg_u32 s24, 0
    s_cbranch_scc1 K2_PJS
    v_exp_f32 v90, v58
    v_exp_f32 v91, v59
    v_exp_f32 v92, v60
    v_exp_f32 v93, v61
    v_exp_f32 v94, v62
    v_exp_f32 v95, v63
    v_exp_f32 v96, v64
    v_exp_f32 v97, v65
    v_pk_add_f32 v[90:91], v[90:91], s[44:45]
    v_pk_add_f32 v[92:93], v[92:93], s[44:45]
    v_pk_fma_f32 v[58:59], v[58:59], v[94:95], v[58:59]
    v_pk_fma_f32 v[60:61], v[60:61], v[96:97], v[60:61]
    v_pk_fma_f32 v[58:59], v[62:63], v[90:91], v[58:59]
    v_pk_fma_f32 v[60:61], v[64:65], v[92:93], v[60:61]
    v_pk_fma_f32 v[90:91], v[90:91], v[94:95], v[90:91]
    v_pk_fma_f32 v[92:93], v[92:93], v[96:97], v[92:93]
    v_pk_mul_f32 v[94:95], v[90:91], v[92:93]
    v_pk_mul_f32 v[58:59], v[58:59], v[92:93]
    v_rcp_f32 v96, v94
    v_rcp_f32 v97, v95
    v_pk_mul_f32 v[60:61], v[60:61], v[90:91]
    v_pk_add_f32 v[126:127], v[94:95], v[126:127]
    v_pk_mul_f32 v[58:59], v[58:59], v[96:97]
    v_pk_mul_f32 v[60:61], v[60:61], v[96:97]
    ds_write_b128 v108, v[58:61] offset:0
    v_exp_f32 v90, v74
    v_exp_f32 v91, v75
    v_exp_f32 v92, v76
    v_exp_f32 v93, v77
    v_exp_f32 v94, v78
    v_exp_f32 v95, v79
    v_exp_f32 v96, v80
    v_exp_f32 v97, v81
    v_pk_add_f32 v[90:91], v[90:91], s[44:45]
    v_pk_add_f32 v[92:93], v[92:93], s[44:45]
    v_pk_fma_f32 v[74:75], v[74:75], v[94:95], v[74:75]
    v_pk_fma_f32 v[76:77], v[76:77], v[96:97], v[76:77]
    v_pk_fma_f32 v[74:75], v[78:79], v[90:91], v[74:75]
    v_pk_fma_f32 v[76:77], v[80:81], v[92:93], v[76:77]
    v_pk_fma_f32 v[90:91], v[90:91], v[94:95], v[90:91]
    v_pk_fma_f32 v[92:93], v[92:93], v[96:97], v[92:93]
    v_pk_mul_f32 v[94:95], v[90:91], v[92:93]
    v_pk_mul_f32 v[74:75], v[74:75], v[92:93]
    v_rcp_f32 v96, v94
    v_rcp_f32 v97, v95
    v_pk_mul_f32 v[76:77], v[76:77], v[90:91]
    v_pk_add_f32 v[126:127], v[94:95], v[126:127]
    v_pk_mul_f32 v[74:75], v[74:75], v[96:97]
    v_pk_mul_f32 v[76:77], v[76:77], v[96:97]
    ds_write_b128 v108, v[74:77] offset:256
    s_cmp_eq_u32 s58, 1
    s_cbranch_scc1 K2_PJ4
    v_exp_f32 v90, v66
    v_exp_f32 v91, v67
    v_exp_f32 v92, v68
    v_exp_f32 v93, v69
    v_exp_f32 v94, v70
    v_exp_f32 v95, v71
    v_exp_f32 v96, v72
    v_exp_f32 v97, v73
    v_pk_add_f32 v[90:91], v[90:91], s[44:45]
    v_pk_add_f32 v[92:93], v[92:93], s[44:45]
    v_pk_fma_f32 v[66:67], v[66:67], v[94:95], v[66:67]
    v_pk_fma_f32 v[68:69], v[68:69], v[96:97], v[68:69]
    v_pk_fma_f32 v[66:67], v[70:71], v[90:91], v[66:67]
    v_pk_fma_f32 v[68:69], v[72:73], v[92:93], v[68:69]
    v_pk_fma_f32 v[90:91], v[90:91], v[94:95], v[90:91]
    v_pk_fma_f32 v[92:93], v[92:93], v[96:97], v[92:93]
    v_pk_mul_f32 v[94:95], v[90:91], v[92:93]
    v_pk_mul_f32 v[66:67], v[66:67], v[92:93]
    v_rcp_f32 v96, v94
    v_rcp_f32 v97, v95
    v_pk_mul_f32 v[68:69], v[68:69], v[90:91]
    v_pk_add_f32 v[126:127], v[94:95], v[126:127]
    v_pk_mul_f32 v[66:67], v[66:67], v[96:97]
    v_pk_mul_f32 v[68:69], v[68:69], v[96:97]
    ds_write_b128 v109, v[66:69] offset:0
    v_exp_f32 v90, v82
    v_exp_f32 v91, v83
    v_exp_f32 v92, v84
    v_exp_f32 v93, v85
    v_exp_f32 v94, v86
    v_exp_f32 v95, v87
    v_exp_f32 v96, v88
    v_exp_f32 v97, v89
    v_pk_add_f32 v[90:91], v[90:91], s[44:45]
    v_pk_add_f32 v[92:93], v[92:93], s[44:45]
    v_pk_fma_f32 v[82:83], v[82:83], v[94:95], v[82:83]
    v_pk_fma_f32 v[84:85], v[84:85], v[96:97], v[84:85]
    v_pk_fma_f32 v[82:83], v[86:87], v[90:91], v[82:83]
    v_pk_fma_f32 v[84:85], v[88:89], v[92:93], v[84:85]
    v_pk_fma_f32 v[90:91], v[90:91], v[94:95], v[90:91]
    v_pk_fma_f32 v[92:93], v[92:93], v[96:97], v[92:93]
    v_pk_mul_f32 v[94:95], v[90:91], v[92:93]
    v_pk_mul_f32 v[82:83], v[82:83], v[92:93]
    v_rcp_f32 v96, v94
    v_rcp_f32 v97, v95
    v_pk_mul_f32 v[84:85], v[84:85], v[90:91]
    v_pk_add_f32 v[126:127], v[94:95], v[126:127]
    v_pk_mul_f32 v[82:83], v[82:83], v[96:97]
    v_pk_mul_f32 v[84:85], v[84:85], v[96:97]
    ds_write_b128 v109, v[82:85] offset:256
K2_PJ4:
    v_cmp_nge_f32 s[4:5], s46, v126
    v_cmp_nge_f32 s[6:7], s46, v127
    s_or_b64 s[4:5], s[4:5], s[6:7]
    s_cbranch_scc1 K2_PJR
K2_PJX:
    v_pk_mul_f32 v[102:103], s[44:45], 0
    v_pk_mul_f32 v[104:105], s[44:45], 0
    v_pk_mul_f32 v[106:107], s[44:45], 0
    v_pk_mul_f32 v[108:109], s[44:45], 0
    s_cmp_eq_u32 s43, 0
    s_cbranch_scc1 K2_RDONE0
K2_GO:
    s_mov_b32 s18, s43
    s_mov_b32 s72, 8
    s_mov_b32 s73, 8
    v_mov_b32 v126, 0
    v_mov_b32 v127, 0
    s_waitcnt vmcnt(0) lgkmcnt(0)
    v_mfma_f32_16x16x32_bf16 v[58:61], v[34:37], v[0:3], v[50:53]
    v_mfma_f32_16x16x32_bf16 v[62:65], v[38:41], v[8:11], v[50:53]
    v_mfma_f32_16x16x32_bf16 v[66:69], v[42:45], v[16:19], v[50:53]
    v_mfma_f32_16x16x32_bf16 v[70:73], v[46:49], v[24:27], v[50:53]
    s_nop 7
.p2align 6
K2_LOOP:
    s_cmp_eq_u32 s43, 1
    v_exp_f32 v90, v58
    v_mfma_f32_16x16x32_bf16 v[74:77], v[32:35], v[4:7], v[54:57]
    v_exp_f32 v91, v59
    v_exp_f32 v92, v60
    v_mfma_f32_16x16x32_bf16 v[78:81], v[36:39], v[12:15], v[54:57]
    v_exp_f32 v93, v61
    v_exp_f32 v94, v62
    v_mfma_f32_16x16x32_bf16 v[82:85], v[40:43], v[20:23], v[54:57]
    v_exp_f32 v95, v63
    v_exp_f32 v96, v64
    v_mfma_f32_16x16x32_bf16 v[86:89], v[44:47], v[28:31], v[54:57]
    v_exp_f32 v97, v65
    s_waitcnt lgkmcnt(0)
    s_cbranch_scc1 K2_NL22
    v_cmp_lt_u32 vcc, s60, v119
    buffer_load_dwordx4 v[2:5], v[110:111], s[32:35], s19 idxen offen sc1
    buffer_load_dwordx4 v[10:13], v[112:113], s[32:35], s19 idxen offen sc1
    buffer_load_dwordx4 v[18:21], v[114:115], s[32:35], s19 idxen offen sc1
    buffer_load_dwordx4 v[26:29], v[116:117], s[32:35], s19 idxen offen sc1
    ds_read_b64 v[34:35], v124 offset:0
    ds_read_b64 v[38:39], v124 offset:16
    ds_read_b64 v[42:43], v124 offset:32
    ds_read_b64 v[46:47], v124 offset:48
    s_cbranch_vccz K2_NQ23
    s_mov_b64 exec, vcc
    v_and_or_b32 v121, v119, s60, v111
    ds_read_b128 v[50:53], v121 offset:34816
    ds_read_b128 v[54:57], v121 offset:35072
    s_mov_b64 exec, -1
K2_NQ23:
    ds_read_u16 v110, v118 offset:8
    ds_read_u16 v112, v118 offset:24
    ds_read_u16 v114, v118 offset:40
    ds_read_u16 v116, v118 offset:56
    ds_read_b32 v124, v123 offset:16
K2_NL22:
    v_exp_f32 v98, v66
    v_exp_f32 v99, v67
    v_exp_f32 v100, v68
    v_exp_f32 v101, v69
    v_pk_add_f32 v[90:91], v[90:91], s[44:45]
    v_pk_add_f32 v[92:93], v[92:93], s[44:45]
    v_pk_fma_f32 v[58:59], v[58:59], v[94:95], v[58:59]
    v_pk_fma_f32 v[60:61], v[60:61], v[96:97], v[60:61]
    v_pk_fma_f32 v[58:59], v[62:63], v[90:91], v[58:59]
    v_pk_fma_f32 v[60:61], v[64:65], v[92:93], v[60:61]
    v_pk_fma_f32 v[90:91], v[90:91], v[94:95], v[90:91]
    v_pk_fma_f32 v[92:93], v[92:93], v[96:97], v[92:93]
    v_exp_f32 v94, v70
    v_exp_f32 v95, v71
    v_exp_f32 v96, v72
    v_exp_f32 v97, v73
    v_pk_fma_f32 v[58:59], v[58:59], v[98:99], v[58:59]
    v_pk_fma_f32 v[60:61], v[60:61], v[100:101], v[60:61]
    v_pk_fma_f32 v[58:59], v[66:67], v[90:91], v[58:59]
    v_pk_fma_f32 v[60:61], v[68:69], v[92:93], v[60:61]
    v_pk_fma_f32 v[90:91], v[90:91], v[98:99], v[90:91]
    v_pk_fma_f32 v[92:93], v[92:93], v[100:101], v[92:93]
    v_pk_fma_f32 v[58:59], v[58:59], v[94:95], v[58:59]
    v_pk_fma_f32 v[60:61], v[60:61], v[96:97], v[60:61]
    v_pk_fma_f32 v[58:59], v[70:71], v[90:91], v[58:59]
    v_pk_fma_f32 v[60:61], v[72:73], v[92:93], v[60:61]
    v_pk_fma_f32 v[90:91], v[90:91], v[94:95], v[90:91]
    v_pk_fma_f32 v[92:93], v[92:93], v[96:97], v[92:93]
    v_pk_mul_f32 v[98:99], v[90:91], v[92:93]
    v_pk_mul_f32 v[58:59], v[58:59], v[92:93]
    v_rcp_f32 v100, v98
    v_rcp_f32 v101, v99
    v_pk_mul_f32 v[60:61], v[60:61], v[90:91]
    v_pk_add_f32 v[126:127], v[98:99], v[126:127]
    v_pk_fma_f32 v[102:103], v[58:59], v[100:101], v[102:103]
    v_pk_fma_f32 v[104:105], v[60:61], v[100:101], v[104:105]
    s_cbranch_scc1 K2_LOOPT
    v_exp_f32 v90, v74
    s_waitcnt vmcnt(3) lgkmcnt(0)
    v_mfma_f32_16x16x32_bf16 v[58:61], v[34:37], v[0:3], v[50:53]
    v_exp_f32 v91, v75
    v_exp_f32 v92, v76
    s_waitcnt vmcnt(2)
    v_mfma_f32_16x16x32_bf16 v[62:65], v[38:41], v[8:11], v[50:53]
    v_exp_f32 v93, v77
    v_exp_f32 v94, v78
    s_waitcnt vmcnt(1)
    v_mfma_f32_16x16x32_bf16 v[66:69], v[42:45], v[16:19], v[50:53]
    v_exp_f32 v95, v79
    v_exp_f32 v96, v80
    s_waitcnt vmcnt(0)
    v_mfma_f32_16x16x32_bf16 v[70:73], v[46:49], v[24:27], v[50:53]
    v_exp_f32 v97, v81
    v_exp_f32 v98, v82
    v_exp_f32 v99, v83
    v_exp_f32 v100, v84
    v_exp_f32 v101, v85
    v_pk_add_f32 v[90:91], v[90:91], s[44:45]
    v_pk_add_f32 v[92:93], v[92:93], s[44:45]
    v_pk_fma_f32 v[74:75], v[74:75], v[94:95], v[74:75]
    v_pk_fma_f32 v[76:77], v[76:77], v[96:97], v[76:77]
    v_pk_fma_f32 v[74:75], v[78:79], v[90:91], v[74:75]
    v_pk_fma_f32 v[76:77], v[80:81], v[92:93], v[76:77]
    v_pk_fma_f32 v[90:91], v[90:91], v[94:95], v[90:91]
    v_pk_fma_f32 v[92:93], v[92:93], v[96:97], v[92:93]
    v_exp_f32 v94, v86
    v_exp_f32 v95, v87
    v_exp_f32 v96, v88
    v_exp_f32 v97, v89
    v_pk_fma_f32 v[74:75], v[74:75], v[98:99], v[74:75]
    v_pk_fma_f32 v[76:77], v[76:77], v[100:101], v[76:77]
    v_pk_fma_f32 v[74:75], v[82:83], v[90:91], v[74:75]
    v_pk_fma_f32 v[76:77], v[84:85], v[92:93], v[76:77]
    v_pk_fma_f32 v[90:91], v[90:91], v[98:99], v[90:91]
    v_pk_fma_f32 v[92:93], v[92:93], v[100:101], v[92:93]
    v_pk_fma_f32 v[74:75], v[74:75], v[94:95], v[74:75]
    v_pk_fma_f32 v[76:77], v[76:77], v[96:97], v[76:77]
    v_pk_fma_f32 v[74:75], v[86:87], v[90:91], v[74:75]
    v_pk_fma_f32 v[76:77], v[88:89], v[92:93], v[76:77]
    v_pk_fma_f32 v[90:91], v[90:91], v[94:95], v[90:91]
    v_pk_fma_f32 v[92:93], v[92:93], v[96:97], v[92:93]
    v_pk_mul_f32 v[98:99], v[90:91], v[92:93]
    v_pk_mul_f32 v[74:75], v[74:75], v[92:93]
    v_rcp_f32 v100, v98
    v_rcp_f32 v101, v99
    v_pk_mul_f32 v[76:77], v[76:77], v[90:91]
    v_pk_add_f32 v[126:127], v[98:99], v[126:127]
    v_pk_fma_f32 v[106:107], v[74:75], v[100:101], v[106:107]
    v_pk_fma_f32 v[108:109], v[76:77], v[100:101], v[108:109]
    s_cbranch_vccz K2_NF24
    s_mov_b64 exec, vcc
    ds_write_b128 v120, v[102:105]
    ds_write_b128 v120, v[106:109] offset:256
    ds_read_b128 v[102:105], v119
    ds_read_b128 v[106:109], v119
    v_add_u32 v120, v125, v121
    s_mov_b64 exec, -1
K2_NF24:
    ds_read2_b32 v[118:119], v122 offset0:6 offset1:5
    v_lshl_add_u64 v[122:123], v[122:123], 0, s[72:73]
    s_sub_u32 s43, s43, 1
    s_cmp_gt_u32 s43, 2
    s_cbranch_scc1 K2_LOOP
    s_branch K2_LOOP
K2_LOOPT:
    s_setprio 2
    v_exp_f32 v90, v74
    v_exp_f32 v91, v75
    v_exp_f32 v92, v76
    v_exp_f32 v93, v77
    v_exp_f32 v94, v78
    v_exp_f32 v95, v79
    v_exp_f32 v96, v80
    v_exp_f32 v97, v81
    v_exp_f32 v98, v82
    v_exp_f32 v99, v83
    v_exp_f32 v100, v84
    v_exp_f32 v101, v85
    v_pk_add_f32 v[90:91], v[90:91], s[44:45]
    v_pk_add_f32 v[92:93], v[92:93], s[44:45]
    v_pk_fma_f32 v[74:75], v[74:75], v[94:95], v[74:75]
    v_pk_fma_f32 v[76:77], v[76:77], v[96:97], v[76:77]
    v_pk_fma_f32 v[74:75], v[78:79], v[90:91], v[74:75]
    v_pk_fma_f32 v[76:77], v[80:81], v[92:93], v[76:77]
    v_pk_fma_f32 v[90:91], v[90:91], v[94:95], v[90:91]
    v_pk_fma_f32 v[92:93], v[92:93], v[96:97], v[92:93]
    v_exp_f32 v94, v86
    v_exp_f32 v95, v87
    v_exp_f32 v96, v88
    v_exp_f32 v97, v89
    v_pk_fma_f32 v[74:75], v[74:75], v[98:99], v[74:75]
    v_pk_fma_f32 v[76:77], v[76:77], v[100:101], v[76:77]
    v_pk_fma_f32 v[74:75], v[82:83], v[90:91], v[74:75]
    v_pk_fma_f32 v[76:77], v[84:85], v[92:93], v[76:77]
    v_pk_fma_f32 v[90:91], v[90:91], v[98:99], v[90:91]
    v_pk_fma_f32 v[92:93], v[92:93], v[100:101], v[92:93]
    v_pk_fma_f32 v[74:75], v[74:75], v[94:95], v[74:75]
    v_pk_fma_f32 v[76:77], v[76:77], v[96:97], v[76:77]
    v_pk_fma_f32 v[74:75], v[86:87], v[90:91], v[74:75]
    v_pk_fma_f32 v[76:77], v[88:89], v[92:93], v[76:77]
    v_pk_fma_f32 v[90:91], v[90:91], v[94:95], v[90:91]
    v_pk_fma_f32 v[92:93], v[92:93], v[96:97], v[92:93]
    v_pk_mul_f32 v[98:99], v[90:91], v[92:93]
    v_pk_mul_f32 v[74:75], v[74:75], v[92:93]
    v_rcp_f32 v100, v98
    v_rcp_f32 v101, v99
    v_pk_mul_f32 v[76:77], v[76:77], v[90:91]
    v_pk_add_f32 v[126:127], v[98:99], v[126:127]
    v_pk_fma_f32 v[106:107], v[74:75], v[100:101], v[106:107]
    v_pk_fma_f32 v[108:109], v[76:77], v[100:101], v[108:109]
    v_cmp_nge_f32 s[4:5], s46, v126
    v_cmp_nge_f32 s[6:7], s46, v127
    s_or_b64 s[4:5], s[4:5], s[6:7]
    s_cbranch_scc1 K2_REDO
K2_FLUSH:
    s_cmp_lt_u32 s3, 10
    s_cbranch_scc1 K2_OSLOW
    s_waitcnt vmcnt(0) lgkmcnt(0)
    ds_write_b128 v120, v[102:105]
    ds_write_b128 v120, v[106:109] offset:256
K2_RDONE:
    s_mov_b64 exec, 1
    v_mov_b32 v116, 0
    v_mov_b32 v114, 1
    ds_add_u32 v116, v114 offset:224
    s_mov_b64 exec, -1
    s_cmp_lg_u32 s41, 0
    s_cbranch_scc1 K2_ROUND
    s_waitcnt lgkmcnt(0)
    s_endpgm
K2_RDONE0:
    s_waitcnt vmcnt(0) lgkmcnt(0)
    s_branch K2_RDONE
K2_PJR:
    s_mov_b32 s24, 1
    s_waitcnt vmcnt(0) lgkmcnt(0)
    s_branch K2_PJ
K2_PJS:
    v_exp_f32 v90, v58
    v_exp_f32 v91, v59
    v_exp_f32 v92, v60
    v_exp_f32 v93, v61
    v_exp_f32 v94, v62
    v_exp_f32 v95, v63
    v_exp_f32 v96, v64
    v_exp_f32 v97, v65
    s_nop 0
    v_pk_add_f32 v[90:91], v[90:91], s[44:45]
    v_pk_add_f32 v[92:93], v[92:93], s[44:45]
    v_pk_add_f32 v[94:95], v[94:95], s[44:45]
    v_pk_add_f32 v[96:97], v[96:97], s[44:45]
    v_rcp_f32 v90, v90
    v_rcp_f32 v91, v91
    v_rcp_f32 v92, v92
    v_rcp_f32 v93, v93
    v_rcp_f32 v94, v94
    v_rcp_f32 v95, v95
    v_rcp_f32 v96, v96
    v_rcp_f32 v97, v97
    s_nop 0
    v_pk_mul_f32 v[58:59], v[58:59], v[90:91]
    v_pk_mul_f32 v[60:61], v[60:61], v[92:93]
    v_pk_fma_f32 v[58:59], v[62:63], v[94:95], v[58:59]
    v_pk_fma_f32 v[60:61], v[64:65], v[96:97], v[60:61]
    ds_write_b128 v108, v[58:61] offset:0
    v_exp_f32 v90, v74
    v_exp_f32 v91, v75
    v_exp_f32 v92, v76
    v_exp_f32 v93, v77
    v_exp_f32 v94, v78
    v_exp_f32 v95, v79
    v_exp_f32 v96, v80
    v_exp_f32 v97, v81
    s_nop 0
    v_pk_add_f32 v[90:91], v[90:91], s[44:45]
    v_pk_add_f32 v[92:93], v[92:93], s[44:45]
    v_pk_add_f32 v[94:95], v[94:95], s[44:45]
    v_pk_add_f32 v[96:97], v[96:97], s[44:45]
    v_rcp_f32 v90, v90
    v_rcp_f32 v91, v91
    v_rcp_f32 v92, v92
    v_rcp_f32 v93, v93
    v_rcp_f32 v94, v94
    v_rcp_f32 v95, v95
    v_rcp_f32 v96, v96
    v_rcp_f32 v97, v97
    s_nop 0
    v_pk_mul_f32 v[74:75], v[74:75], v[90:91]
    v_pk_mul_f32 v[76:77], v[76:77], v[92:93]
    v_pk_fma_f32 v[74:75], v[78:79], v[94:95], v[74:75]
    v_pk_fma_f32 v[76:77], v[80:81], v[96:97], v[76:77]
    ds_write_b128 v108, v[74:77] offset:256
    s_cmp_eq_u32 s58, 1
    s_cbranch_scc1 K2_PJX
    v_exp_f32 v90, v66
    v_exp_f32 v91, v67
    v_exp_f32 v92, v68
    v_exp_f32 v93, v69
    v_exp_f32 v94, v70
    v_exp_f32 v95, v71
    v_exp_f32 v96, v72
    v_exp_f32 v97, v73
    s_nop 0
    v_pk_add_f32 v[90:91], v[90:91], s[44:45]
    v_pk_add_f32 v[92:93], v[92:93], s[44:45]
    v_pk_add_f32 v[94:95], v[94:95], s[44:45]
    v_pk_add_f32 v[96:97], v[96:97], s[44:45]
    v_rcp_f32 v90, v90
    v_rcp_f32 v91, v91
    v_rcp_f32 v92, v92
    v_rcp_f32 v93, v93
    v_rcp_f32 v94, v94
    v_rcp_f32 v95, v95
    v_rcp_f32 v96, v96
    v_rcp_f32 v97, v97
    s_nop 0
    v_pk_mul_f32 v[66:67], v[66:67], v[90:91]
    v_pk_mul_f32 v[68:69], v[68:69], v[92:93]
    v_pk_fma_f32 v[66:67], v[70:71], v[94:95], v[66:67]
    v_pk_fma_f32 v[68:69], v[72:73], v[96:97], v[68:69]
    ds_write_b128 v109, v[66:69] offset:0
    v_exp_f32 v90, v82
    v_exp_f32 v91, v83
    v_exp_f32 v92, v84
    v_exp_f32 v93, v85
    v_exp_f32 v94, v86
    v_exp_f32 v95, v87
    v_exp_f32 v96, v88
    v_exp_f32 v97, v89
    s_nop 0
    v_pk_add_f32 v[90:91], v[90:91], s[44:45]
    v_pk_add_f32 v[92:93], v[92:93], s[44:45]
    v_pk_add_f32 v[94:95], v[94:95], s[44:45]
    v_pk_add_f32 v[96:97], v[96:97], s[44:45]
    v_rcp_f32 v90, v90
    v_rcp_f32 v91, v91
    v_rcp_f32 v92, v92
    v_rcp_f32 v93, v93
    v_rcp_f32 v94, v94
    v_rcp_f32 v95, v95
    v_rcp_f32 v96, v96
    v_rcp_f32 v97, v97
    s_nop 0
    v_pk_mul_f32 v[82:83], v[82:83], v[90:91]
    v_pk_mul_f32 v[84:85], v[84:85], v[92:93]
    v_pk_fma_f32 v[82:83], v[86:87], v[94:95], v[82:83]
    v_pk_fma_f32 v[84:85], v[88:89], v[96:97], v[84:85]
    ds_write_b128 v109, v[82:85] offset:256
    s_branch K2_PJX
K_OTHER:
    s_sub_u32 s40, s62, 252
    s_cbranch_scc1 K_END
    s_load_dwordx2 s[8:9], s[0:1], 40
    v_and_b32 v127, 63, v0
    v_lshrrev_b32 v122, 4, v127
    v_and_b32 v123, 15, v127
    v_xor_b32 v3, v123, v122
    v_lshlrev_b32 v3, 4, v3
    v_lshl_add_u32 v5, v122, 8, v3
    s_lshl_b32 s56, s3, 6
    v_lshrrev_b32 v6, 1, v123
    v_xor_b32 v6, v6, v122
    v_lshlrev_b32 v6, 5, v6
    v_lshl_add_u32 v6, v122, 8, v6
    v_and_b32 v7, 1, v127
    v_lshl_add_u32 v6, v7, 4, v6
    s_and_b32 s56, s56, 128
    v_xor_b32 v6, s56, v6
    s_lshl_b32 s57, s3, 10
    s_add_u32 s58, s57, 16384
    s_mov_b32 s10, 0x10000
    s_mov_b32 s11, 0x20000
    s_mov_b32 s30, 0x10000000
    s_mov_b32 s31, 0x20000
    v_mov_b32 v9, 0
    s_lshr_b32 s41, s40, 1
    s_lshl_b32 s41, s41, 15
    s_waitcnt lgkmcnt(0)
K_PREP:
    s_add_u32 s56, s57, s41
    s_add_u32 m0, s57, 1024
    s_nop 0
    buffer_load_dwordx4 v6, s[8:11], s56 offen lds
    s_add_u32 s56, s58, s41
    s_add_u32 m0, s58, 1024
    s_nop 0
    buffer_load_dwordx4 v6, s[8:11], s56 offen lds
    v_lshrrev_b32 v10, 2, v123
    v_and_b32 v11, 3, v127
    v_lshl_add_u32 v10, v122, 3, v10
    v_lshlrev_b32 v16, 4, v127
    s_and_b32 s42, s40, 1
    s_lshl4_add_u32 s42, s42, s3
    s_lshr_b32 s43, s42, 2
    s_and_b32 s61, s42, 3
    s_lshl_b32 s56, s61, 5
    s_add_u32 s56, s56, 0
    v_add_u32 v13, s56, v10
    s_cmp_eq_u32 s41, 0
    s_cbranch_scc1 KR_A0
    v_and_b32 v15, 64, v13
    v_bfe_u32 v14, v13, 2, 4
    v_or_b32 v15, v15, v14
    v_and_b32 v13, 3, v13
    v_lshl_add_u32 v13, v13, 4, v15
KR_A0:
    v_bfe_u32 v14, v13, 3, 1
    v_and_b32 v15, 3, v13
    v_lshl_or_b32 v14, v14, 2, v15
    v_xor_b32 v14, s43, v14
    v_lshlrev_b32 v14, 5, v14
    v_lshl_add_u32 v14, v11, 3, v14
    v_lshl_add_u32 v17, v13, 8, v14
    s_lshl_b32 s56, s61, 5
    s_add_u32 s56, s56, 4
    v_add_u32 v13, s56, v10
    s_cmp_eq_u32 s41, 0
    s_cbranch_scc1 KR_A1
    v_and_b32 v15, 64, v13
    v_bfe_u32 v14, v13, 2, 4
    v_or_b32 v15, v15, v14
    v_and_b32 v13, 3, v13
    v_lshl_add_u32 v13, v13, 4, v15
KR_A1:
    v_bfe_u32 v14, v13, 3, 1
    v_and_b32 v15, 3, v13
    v_lshl_or_b32 v14, v14, 2, v15
    v_xor_b32 v14, s43, v14
    v_lshlrev_b32 v14, 5, v14
    v_lshl_add_u32 v14, v11, 3, v14
    v_lshl_add_u32 v18, v13, 8, v14
    s_lshl_b32 s42, s42, 10
    s_add_u32 s42, s42, s41
    s_add_u32 s42, s42, 0x820000
    s_cmp_lg_u32 s3, 0
    s_cbranch_scc1 KR_B
    s_memrealtime s[10:11]
    s_sleep 14
    s_load_dword s47, s[64:65], 0
    s_waitcnt lgkmcnt(0)
    s_sub_u32 s56, s10, s47
    s_add_u32 s56, s56, 0x100000
    s_and_b32 s56, s56, 0x7fe00000
    s_lshr_b32 s57, s47, 31
    s_cmp_lt_u32 s56, s57
    s_cbranch_scc1 KR_TAG
    s_load_dword s47, s[64:65], 64
    s_waitcnt lgkmcnt(0)
    s_sub_u32 s56, s10, s47
    s_add_u32 s56, s56, 0x100000
    s_and_b32 s56, s56, 0x7fe00000
    s_lshr_b32 s57, s47, 31
    s_cmp_lt_u32 s56, s57
    s_cbranch_scc1 KR_TAG
    s_load_dword s47, s[64:65], 128
    s_waitcnt lgkmcnt(0)
    s_sub_u32 s56, s10, s47
    s_add_u32 s56, s56, 0x100000
    s_and_b32 s56, s56, 0x7fe00000
    s_lshr_b32 s57, s47, 31
    s_cmp_lt_u32 s56, s57
    s_cbranch_scc1 KR_TAG
    s_load_dword s47, s[64:65], 192
    s_waitcnt lgkmcnt(0)
    s_sub_u32 s56, s10, s47
    s_add_u32 s56, s56, 0x100000
    s_and_b32 s56, s56, 0x7fe00000
    s_lshr_b32 s57, s47, 31
    s_cmp_lt_u32 s56, s57
    s_cbranch_scc1 KR_TAG
    s_mov_b32 s59, 65536
K_TAGL25:
    buffer_load_dword v2, v8, s[64:67], 0 offen sc1
    s_sub_u32 s59, s59, 1
    s_cbranch_scc1 K_END
    s_waitcnt vmcnt(0)
    v_readfirstlane_b32 s47, v2
    s_sub_u32 s56, s10, s47
    s_add_u32 s56, s56, 0x100000
    s_and_b32 s56, s56, 0x7fe00000
    s_lshr_b32 s57, s47, 31
    s_cmp_lt_u32 s56, s57
    s_cbranch_scc0 K_TAGL25
KR_TAG:
    v_mov_b32 v9, s47
    ds_write_b32 v8, v9 offset:192
KR_B:
    s_waitcnt vmcnt(0) lgkmcnt(0)
    s_barrier
    ds_read_b32 v9, v8 offset:192
    ds_read_b64_tr_b16 v[20:21], v17 offset:1024
    ds_read_b64_tr_b16 v[22:23], v18 offset:1024
    s_waitcnt lgkmcnt(2)
    v_readfirstlane_b32 s47, v9
    s_lshl_b32 s19, s47, 28
    s_lshr_b32 s19, s19, 4
    s_add_u32 s42, s42, s19
    s_waitcnt lgkmcnt(0)
    buffer_store_dwordx4 v[20:23], v16, s[28:31], s42 offen sc1
    s_cmp_eq_u32 s3, 0
    s_cbranch_scc1 KR_PUB
    s_waitcnt vmcnt(0)
    s_barrier
    s_endpgm
KR_PUB:
    s_lshl_b32 s56, s40, 6
    s_add_u32 s56, s56, s19
    s_add_u32 s56, s56, 0x810000
    v_mov_b32 v12, s47
    v_mov_b32 v13, s47
    v_mov_b32 v14, s47
    v_mov_b32 v15, s47
    s_waitcnt vmcnt(0) lgkmcnt(0)
    s_barrier
    s_mov_b64 exec, 0xf
    buffer_store_dwordx4 v[12:15], v16, s[28:31], s56 offen sc1
K_LAST:
    s_endpgm
.section .rodata,"a"
.p2align 6
.amdhsa_kernel standalone__mpnn_edge_mlp__graph_kernel
  .amdhsa_next_free_vgpr 128
  .amdhsa_next_free_sgpr 80
  .amdhsa_accum_offset 128
  .amdhsa_group_segment_fixed_size 0
  .amdhsa_kernarg_size 72
  .amdhsa_user_sgpr_count 2
  .amdhsa_user_sgpr_kernarg_segment_ptr 1
  .amdhsa_system_sgpr_workgroup_id_x 1
.end_amdhsa_kernel
```
